```python
import torch

def _softmax(x, axis=-1):
    return torch.softmax(x, dim=axis)
def _gelu(x):
    return torch.nn.functional.gelu(x, approximate="tanh")
def _silu(x):
    return torch.nn.functional.silu(x)
def _sigmoid(x):
    return torch.sigmoid(x)
def _layernorm(x, axis=-1, eps=1e-5):
    m = x.mean(dim=axis, keepdim=True)
    v = x.var(dim=axis, keepdim=True, unbiased=False)
    return (x - m) / torch.sqrt(v + eps)
def _scatter_add(tgt, idx, src, axis=0):
    return tgt.clone().index_add_(axis, idx, src)
def _segment_sum(src, seg, n):
    out = torch.zeros((n,) + src.shape[1:], dtype=src.dtype)
    return out.index_add_(0, seg, src)
def _pad(x, pw):
    flat = tuple(v for pair in reversed(pw) for v in pair)
    return torch.nn.functional.pad(x, flat)

kernel_name = 'recurrent_scan__spectral_gfnet__dense_activation_gelu__prompt'

def setup_inputs():

    _w = (lambda a: (lambda t: t.to(torch.bfloat16) if t.is_floating_point() else t)(torch.as_tensor(a)))
    def _A_setup():
        B, S, D = 1, 2048, 640
        Df = D // 2 + 1
        return {
            "x": _w((lambda *s: torch.randn(*s, dtype=torch.bfloat16) * 0.05)(B, S, D)),
            "w_r": _w((lambda *s: torch.randn(*s, dtype=torch.bfloat16) * 3.2)(S, Df) * 0.02),
            "w_i": _w((lambda *s: torch.randn(*s, dtype=torch.bfloat16) * 3.2)(S, Df) * 0.02),
        }
    _A_in = _A_setup()

    def _B_setup():
        B, S, D, F = 1, 2048, 640, 1728
        return {
            "x": _w((lambda *s: torch.randn(*s, dtype=torch.bfloat16) * 0.05)(B, S, D)),
            "w1": _w((lambda *s: torch.randn(*s, dtype=torch.bfloat16) * 3.2)(D, F) * (D ** -0.5)),
            "b1": _w((lambda *s: torch.randn(*s, dtype=torch.bfloat16) * 3.2)(F) * 0.01),
            "w2": _w((lambda *s: torch.randn(*s, dtype=torch.bfloat16) * 0.4)(F, D) * (F ** -0.5)),
            "b2": _w((lambda *s: torch.randn(*s, dtype=torch.bfloat16) * 0.4)(D) * 0.01),
        }
    _B_in = _B_setup()

    return {
        "A_x": _A_in["x"],
        "A_w_r": _A_in["w_r"],
        "A_w_i": _A_in["w_i"],
        "B_x": _B_in["x"],
        "B_w1": _B_in["w1"],
        "B_b1": _B_in["b1"],
        "B_w2": _B_in["w2"],
        "B_b2": _B_in["b2"],
    }

def reference(A_x, A_w_r, A_w_i, B_x, B_w1, B_b1, B_w2, B_b2):
    def _A_ref(x, w_r, w_i):
        B, S, D = x.shape
        X = (lambda x, axes=(-2,-1): torch.fft.rfft2(x.float(), dim=axes))(x, axes=(-2, -1))
        W = w_r + 1j * w_i
        X = X * W
        y = (lambda x, s, axes=(-2,-1): torch.fft.irfft2(x, s=s, dim=axes).to(torch.bfloat16))(X, (S, D), axes=(-2, -1))
        return y

    def _B_ref(x, w1, b1, w2, b2):
        h = torch.einsum("bsd,df->bsf", x, w1) + b1
        h = _gelu(h)
        return torch.einsum("bsf,fd->bsd", h, w2) + b2

    x = A_x
    xn = _layernorm(x, axis=-1)
    s = _A_ref(xn, A_w_r, A_w_i)
    g = _silu(_B_ref(xn, B_w1, B_b1, B_w2, B_b2))
    return x + s * g
```

```asm
; @launch grid=(256,1,1) block=(512,1,1) lds=163840
.amdgcn_target "amdgcn-amd-amdhsa--gfx950"
.text
.globl recurrent_scan__spectral_gfnet__dense_activation_gelu__prompt_kernel
.p2align 8
.type recurrent_scan__spectral_gfnet__dense_activation_gelu__prompt_kernel,@function
recurrent_scan__spectral_gfnet__dense_activation_gelu__prompt_kernel:
    s_cmp_ge_u32 s2, 256
    s_cbranch_scc1 Lk1_end_x
    s_load_dwordx2 s[4:5], s[0:1], 0
    s_load_dwordx4 s[8:11], s[0:1], 32
    s_load_dwordx2 s[6:7], s[0:1], 80
    s_load_dwordx2 s[50:51], s[0:1], 72
    s_load_dwordx2 s[36:37], s[0:1], 56
    v_lshrrev_b32 v1, 6, v0
    v_and_b32 v0, 63, v0
    v_readfirstlane_b32 s28, v1
    s_and_b32 s31, s2, 7
    s_lshr_b32 s32, s2, 3
    v_mov_b32 v2, 131072
    v_mov_b32 v3, 0
    ds_write_b32 v2, v3
    s_lshl_b32 s33, s32, 3
    s_add_u32 s33, s33, s28
    s_cmp_ge_u32 s33, 5
    s_cbranch_scc1 Lk1_nc
    s_getpc_b64 s[56:57]
Lcpf1:
    s_add_u32 s56, s56, recurrent_scan__spectral_gfnet__dense_activation_gelu__prompt_kernel-Lcpf1
    s_addc_u32 s57, s57, (recurrent_scan__spectral_gfnet__dense_activation_gelu__prompt_kernel-Lcpf1)>>32
    v_lshlrev_b32 v14, 7, v0
    s_lshl_b32 s58, s28, 13
    v_add_u32 v14, s58, v14
    v_min_u32 v14, Lk1_end-recurrent_scan__spectral_gfnet__dense_activation_gelu__prompt_kernel, v14
    v_mov_b32 v15, s57
    v_add_co_u32 v14, vcc, s56, v14
    s_nop 1
    v_addc_co_u32 v15, vcc, 0, v15, vcc
    global_load_dword v253, v[14:15], off
Lk1_nc:
    s_cmp_ge_u32 s32, 28
    s_cbranch_scc1 Lp1
    s_lshr_b32 s29, s31, 1
    s_lshl_b32 s29, s29, 2
    s_and_b32 s33, s32, 3
    s_add_u32 s29, s29, s33
    s_and_b32 s30, s31, 1
    s_mul_i32 s30, s30, 7
    s_lshr_b32 s33, s32, 2
    s_add_u32 s30, s30, s33
    s_cmp_lt_u32 s28, 4
    s_cbranch_scc1 Lg1c
    s_sub_u32 s33, s28, 4
    v_lshrrev_b32 v1, 3, v0
    v_and_b32 v2, 7, v0
    v_lshrrev_b32 v3, 4, v0
    s_lshl_b32 s34, s29, 2
    s_add_u32 s34, s34, s33
    v_lshl_add_u32 v1, v1, 6, s34
    v_mul_u32_u24 v1, 1280, v1
    v_xor_b32 v8, v2, v3
    v_xor_b32 v9, 4, v8
    v_lshl_add_u32 v4, v8, 4, v1
    v_lshl_add_u32 v5, v9, 4, v1
    v_add_u32 v5, 655360, v5
    v_add_u32 v6, 1310720, v4
    v_add_u32 v7, 1310720, v5
    v_and_b32 v2, 15, v0
    v_lshlrev_b32 v8, 2, v3
    v_xor_b32 v2, v2, v8
    s_lshl_b32 s34, s33, 4
    v_add_u32 v8, s34, v3
    v_mul_u32_u24 v8, 3456, v8
    s_lshl_b32 s34, s30, 8
    v_lshl_add_u32 v10, v2, 4, v8
    v_add_u32 v10, s34, v10
    s_cmp_eq_u32 s30, 13
    s_cselect_b32 s34, 8, 16
    v_cmp_le_u32 vcc, s34, v2
    v_mov_b32 v8, 0x80000000
    s_nop 0
    v_cndmask_b32 v10, v10, v8, vcc
    s_lshl_b32 s40, s33, 12
    s_mov_b32 s43, 0
    s_waitcnt lgkmcnt(0)
    s_mov_b32 s12, s4
    s_mov_b32 s13, s5
    s_mov_b32 s14, 2621440
    s_mov_b32 s15, 0x00020000
    s_mov_b32 s16, s8
    s_mov_b32 s17, s9
    s_mov_b32 s18, 2211840
    s_mov_b32 s19, 0x00020000
    s_lshl_b32 s41, s43, 7
    s_mul_i32 s42, s43, 221184
    s_add_u32 m0, s40, 0
    s_nop 0
    buffer_load_dwordx4 v4, s[12:15], s41 offen lds
    s_add_u32 m0, s40, 16384
    s_nop 0
    buffer_load_dwordx4 v10, s[16:19], s42 offen lds
    s_add_u32 s42, s42, 13824
    s_add_u32 m0, s40, 1024
    s_nop 0
    buffer_load_dwordx4 v5, s[12:15], s41 offen lds
    s_add_u32 m0, s40, 17408
    s_nop 0
    buffer_load_dwordx4 v10, s[16:19], s42 offen lds
    s_add_u32 s42, s42, 13824
    s_add_u32 m0, s40, 2048
    s_nop 0
    buffer_load_dwordx4 v6, s[12:15], s41 offen lds
    s_add_u32 m0, s40, 18432
    s_nop 0
    buffer_load_dwordx4 v10, s[16:19], s42 offen lds
    s_add_u32 s42, s42, 13824
    s_add_u32 m0, s40, 3072
    s_nop 0
    buffer_load_dwordx4 v7, s[12:15], s41 offen lds
    s_add_u32 m0, s40, 19456
    s_nop 0
    buffer_load_dwordx4 v10, s[16:19], s42 offen lds
    s_mul_i32 s43, s31, 9
    s_lshr_b32 s43, s43, 3
    s_add_u32 s43, s43, 1
    s_lshl_b32 s41, s43, 7
    s_mul_i32 s42, s43, 221184
    s_add_u32 m0, s40, 32768
    s_nop 0
    buffer_load_dwordx4 v4, s[12:15], s41 offen lds
    s_add_u32 m0, s40, 49152
    s_nop 0
    buffer_load_dwordx4 v10, s[16:19], s42 offen lds
    s_add_u32 s42, s42, 13824
    s_add_u32 m0, s40, 33792
    s_nop 0
    buffer_load_dwordx4 v5, s[12:15], s41 offen lds
    s_add_u32 m0, s40, 50176
    s_nop 0
    buffer_load_dwordx4 v10, s[16:19], s42 offen lds
    s_add_u32 s42, s42, 13824
    s_add_u32 m0, s40, 34816
    s_nop 0
    buffer_load_dwordx4 v6, s[12:15], s41 offen lds
    s_add_u32 m0, s40, 51200
    s_nop 0
    buffer_load_dwordx4 v10, s[16:19], s42 offen lds
    s_add_u32 s42, s42, 13824
    s_add_u32 m0, s40, 35840
    s_nop 0
    buffer_load_dwordx4 v7, s[12:15], s41 offen lds
    s_add_u32 m0, s40, 52224
    s_nop 0
    buffer_load_dwordx4 v10, s[16:19], s42 offen lds
    s_add_u32 s43, s43, 1
    s_cmp_eq_u32 s43, 10
    s_cselect_b32 s43, 1, s43
    s_waitcnt vmcnt(8)
    s_barrier
    s_lshl_b32 s41, s43, 7
    s_mul_i32 s42, s43, 221184
    s_add_u32 m0, s40, 65536
    s_nop 0
    buffer_load_dwordx4 v4, s[12:15], s41 offen lds
    s_add_u32 m0, s40, 81920
    s_nop 0
    buffer_load_dwordx4 v10, s[16:19], s42 offen lds
    s_add_u32 s42, s42, 13824
    s_add_u32 m0, s40, 66560
    s_nop 0
    buffer_load_dwordx4 v5, s[12:15], s41 offen lds
    s_add_u32 m0, s40, 82944
    s_nop 0
    buffer_load_dwordx4 v10, s[16:19], s42 offen lds
    s_add_u32 s42, s42, 13824
    s_add_u32 m0, s40, 67584
    s_nop 0
    buffer_load_dwordx4 v6, s[12:15], s41 offen lds
    s_add_u32 m0, s40, 83968
    s_nop 0
    buffer_load_dwordx4 v10, s[16:19], s42 offen lds
    s_add_u32 s42, s42, 13824
    s_add_u32 m0, s40, 68608
    s_nop 0
    buffer_load_dwordx4 v7, s[12:15], s41 offen lds
    s_add_u32 m0, s40, 84992
    s_nop 0
    buffer_load_dwordx4 v10, s[16:19], s42 offen lds
    s_add_u32 s43, s43, 1
    s_cmp_eq_u32 s43, 10
    s_cselect_b32 s43, 1, s43
    s_waitcnt vmcnt(8)
    s_barrier
    s_lshl_b32 s41, s43, 7
    s_mul_i32 s42, s43, 221184
    s_add_u32 m0, s40, 98304
    s_nop 0
    buffer_load_dwordx4 v4, s[12:15], s41 offen lds
    s_add_u32 m0, s40, 114688
    s_nop 0
    buffer_load_dwordx4 v10, s[16:19], s42 offen lds
    s_add_u32 s42, s42, 13824
    s_add_u32 m0, s40, 99328
    s_nop 0
    buffer_load_dwordx4 v5, s[12:15], s41 offen lds
    s_add_u32 m0, s40, 115712
    s_nop 0
    buffer_load_dwordx4 v10, s[16:19], s42 offen lds
    s_add_u32 s42, s42, 13824
    s_add_u32 m0, s40, 100352
    s_nop 0
    buffer_load_dwordx4 v6, s[12:15], s41 offen lds
    s_add_u32 m0, s40, 116736
    s_nop 0
    buffer_load_dwordx4 v10, s[16:19], s42 offen lds
    s_add_u32 s42, s42, 13824
    s_add_u32 m0, s40, 101376
    s_nop 0
    buffer_load_dwordx4 v7, s[12:15], s41 offen lds
    s_add_u32 m0, s40, 117760
    s_nop 0
    buffer_load_dwordx4 v10, s[16:19], s42 offen lds
    s_add_u32 s43, s43, 1
    s_cmp_eq_u32 s43, 10
    s_cselect_b32 s43, 1, s43
    s_waitcnt vmcnt(8)
    s_barrier
    s_lshl_b32 s41, s43, 7
    s_mul_i32 s42, s43, 221184
    s_add_u32 m0, s40, 0
    s_nop 0
    buffer_load_dwordx4 v4, s[12:15], s41 offen lds
    s_add_u32 m0, s40, 16384
    s_nop 0
    buffer_load_dwordx4 v10, s[16:19], s42 offen lds
    s_add_u32 s42, s42, 13824
    s_add_u32 m0, s40, 1024
    s_nop 0
    buffer_load_dwordx4 v5, s[12:15], s41 offen lds
    s_add_u32 m0, s40, 17408
    s_nop 0
    buffer_load_dwordx4 v10, s[16:19], s42 offen lds
    s_add_u32 s42, s42, 13824
    s_add_u32 m0, s40, 2048
    s_nop 0
    buffer_load_dwordx4 v6, s[12:15], s41 offen lds
    s_add_u32 m0, s40, 18432
    s_nop 0
    buffer_load_dwordx4 v10, s[16:19], s42 offen lds
    s_add_u32 s42, s42, 13824
    s_add_u32 m0, s40, 3072
    s_nop 0
    buffer_load_dwordx4 v7, s[12:15], s41 offen lds
    s_add_u32 m0, s40, 19456
    s_nop 0
    buffer_load_dwordx4 v10, s[16:19], s42 offen lds
    s_add_u32 s43, s43, 1
    s_cmp_eq_u32 s43, 10
    s_cselect_b32 s43, 1, s43
    s_waitcnt vmcnt(8)
    s_barrier
    s_lshl_b32 s41, s43, 7
    s_mul_i32 s42, s43, 221184
    s_add_u32 m0, s40, 32768
    s_nop 0
    buffer_load_dwordx4 v4, s[12:15], s41 offen lds
    s_add_u32 m0, s40, 49152
    s_nop 0
    buffer_load_dwordx4 v10, s[16:19], s42 offen lds
    s_add_u32 s42, s42, 13824
    s_add_u32 m0, s40, 33792
    s_nop 0
    buffer_load_dwordx4 v5, s[12:15], s41 offen lds
    s_add_u32 m0, s40, 50176
    s_nop 0
    buffer_load_dwordx4 v10, s[16:19], s42 offen lds
    s_add_u32 s42, s42, 13824
    s_add_u32 m0, s40, 34816
    s_nop 0
    buffer_load_dwordx4 v6, s[12:15], s41 offen lds
    s_add_u32 m0, s40, 51200
    s_nop 0
    buffer_load_dwordx4 v10, s[16:19], s42 offen lds
    s_add_u32 s42, s42, 13824
    s_add_u32 m0, s40, 35840
    s_nop 0
    buffer_load_dwordx4 v7, s[12:15], s41 offen lds
    s_add_u32 m0, s40, 52224
    s_nop 0
    buffer_load_dwordx4 v10, s[16:19], s42 offen lds
    s_add_u32 s43, s43, 1
    s_cmp_eq_u32 s43, 10
    s_cselect_b32 s43, 1, s43
    s_waitcnt vmcnt(8)
    s_barrier
    s_lshl_b32 s41, s43, 7
    s_mul_i32 s42, s43, 221184
    s_add_u32 m0, s40, 65536
    s_nop 0
    buffer_load_dwordx4 v4, s[12:15], s41 offen lds
    s_add_u32 m0, s40, 81920
    s_nop 0
    buffer_load_dwordx4 v10, s[16:19], s42 offen lds
    s_add_u32 s42, s42, 13824
    s_add_u32 m0, s40, 66560
    s_nop 0
    buffer_load_dwordx4 v5, s[12:15], s41 offen lds
    s_add_u32 m0, s40, 82944
    s_nop 0
    buffer_load_dwordx4 v10, s[16:19], s42 offen lds
    s_add_u32 s42, s42, 13824
    s_add_u32 m0, s40, 67584
    s_nop 0
    buffer_load_dwordx4 v6, s[12:15], s41 offen lds
    s_add_u32 m0, s40, 83968
    s_nop 0
    buffer_load_dwordx4 v10, s[16:19], s42 offen lds
    s_add_u32 s42, s42, 13824
    s_add_u32 m0, s40, 68608
    s_nop 0
    buffer_load_dwordx4 v7, s[12:15], s41 offen lds
    s_add_u32 m0, s40, 84992
    s_nop 0
    buffer_load_dwordx4 v10, s[16:19], s42 offen lds
    s_add_u32 s43, s43, 1
    s_cmp_eq_u32 s43, 10
    s_cselect_b32 s43, 1, s43
    s_waitcnt vmcnt(8)
    s_barrier
    s_lshl_b32 s41, s43, 7
    s_mul_i32 s42, s43, 221184
    s_add_u32 m0, s40, 98304
    s_nop 0
    buffer_load_dwordx4 v4, s[12:15], s41 offen lds
    s_add_u32 m0, s40, 114688
    s_nop 0
    buffer_load_dwordx4 v10, s[16:19], s42 offen lds
    s_add_u32 s42, s42, 13824
    s_add_u32 m0, s40, 99328
    s_nop 0
    buffer_load_dwordx4 v5, s[12:15], s41 offen lds
    s_add_u32 m0, s40, 115712
    s_nop 0
    buffer_load_dwordx4 v10, s[16:19], s42 offen lds
    s_add_u32 s42, s42, 13824
    s_add_u32 m0, s40, 100352
    s_nop 0
    buffer_load_dwordx4 v6, s[12:15], s41 offen lds
    s_add_u32 m0, s40, 116736
    s_nop 0
    buffer_load_dwordx4 v10, s[16:19], s42 offen lds
    s_add_u32 s42, s42, 13824
    s_add_u32 m0, s40, 101376
    s_nop 0
    buffer_load_dwordx4 v7, s[12:15], s41 offen lds
    s_add_u32 m0, s40, 117760
    s_nop 0
    buffer_load_dwordx4 v10, s[16:19], s42 offen lds
    s_add_u32 s43, s43, 1
    s_cmp_eq_u32 s43, 10
    s_cselect_b32 s43, 1, s43
    s_waitcnt vmcnt(8)
    s_barrier
    s_lshl_b32 s41, s43, 7
    s_mul_i32 s42, s43, 221184
    s_add_u32 m0, s40, 0
    s_nop 0
    buffer_load_dwordx4 v4, s[12:15], s41 offen lds
    s_add_u32 m0, s40, 16384
    s_nop 0
    buffer_load_dwordx4 v10, s[16:19], s42 offen lds
    s_add_u32 s42, s42, 13824
    s_add_u32 m0, s40, 1024
    s_nop 0
    buffer_load_dwordx4 v5, s[12:15], s41 offen lds
    s_add_u32 m0, s40, 17408
    s_nop 0
    buffer_load_dwordx4 v10, s[16:19], s42 offen lds
    s_add_u32 s42, s42, 13824
    s_add_u32 m0, s40, 2048
    s_nop 0
    buffer_load_dwordx4 v6, s[12:15], s41 offen lds
    s_add_u32 m0, s40, 18432
    s_nop 0
    buffer_load_dwordx4 v10, s[16:19], s42 offen lds
    s_add_u32 s42, s42, 13824
    s_add_u32 m0, s40, 3072
    s_nop 0
    buffer_load_dwordx4 v7, s[12:15], s41 offen lds
    s_add_u32 m0, s40, 19456
    s_nop 0
    buffer_load_dwordx4 v10, s[16:19], s42 offen lds
    s_add_u32 s43, s43, 1
    s_cmp_eq_u32 s43, 10
    s_cselect_b32 s43, 1, s43
    s_waitcnt vmcnt(8)
    s_barrier
    s_lshl_b32 s41, s43, 7
    s_mul_i32 s42, s43, 221184
    s_add_u32 m0, s40, 32768
    s_nop 0
    buffer_load_dwordx4 v4, s[12:15], s41 offen lds
    s_add_u32 m0, s40, 49152
    s_nop 0
    buffer_load_dwordx4 v10, s[16:19], s42 offen lds
    s_add_u32 s42, s42, 13824
    s_add_u32 m0, s40, 33792
    s_nop 0
    buffer_load_dwordx4 v5, s[12:15], s41 offen lds
    s_add_u32 m0, s40, 50176
    s_nop 0
    buffer_load_dwordx4 v10, s[16:19], s42 offen lds
    s_add_u32 s42, s42, 13824
    s_add_u32 m0, s40, 34816
    s_nop 0
    buffer_load_dwordx4 v6, s[12:15], s41 offen lds
    s_add_u32 m0, s40, 51200
    s_nop 0
    buffer_load_dwordx4 v10, s[16:19], s42 offen lds
    s_add_u32 s42, s42, 13824
    s_add_u32 m0, s40, 35840
    s_nop 0
    buffer_load_dwordx4 v7, s[12:15], s41 offen lds
    s_add_u32 m0, s40, 52224
    s_nop 0
    buffer_load_dwordx4 v10, s[16:19], s42 offen lds
    s_add_u32 s43, s43, 1
    s_cmp_eq_u32 s43, 10
    s_cselect_b32 s43, 1, s43
    s_load_dwordx4 s[44:47], s[0:1], 8
    s_load_dwordx2 s[48:49], s[0:1], 48
    s_lshl_b32 s34, s2, 1
    s_add_u32 s34, s34, s33
    s_cmp_lt_u32 s33, 2
    s_cselect_b32 s34, s34, s2
    s_cselect_b32 s35, 39, 46
    s_mul_i32 s34, s34, s35
    s_lshl_b32 s34, s34, 7
    v_lshl_add_u32 v11, v0, 7, s34
    v_cmp_le_u32 vcc, s35, v0
    v_mov_b32 v13, 0x80000000
    s_nop 0
    v_cndmask_b32 v11, v11, v13, vcc
    s_waitcnt lgkmcnt(0)
    s_cmp_eq_u32 s33, 2
    s_cselect_b32 s20, s44, s46
    s_cselect_b32 s21, s45, s47
    s_cmp_lt_u32 s33, 2
    s_cselect_b32 s20, s48, s20
    s_cselect_b32 s21, s49, s21
    s_mov_b32 s22, 2211840
    s_cselect_b32 s22, s22, 1314816
    s_mov_b32 s23, 0x00020000
    v_mov_b32 v12, 0
    s_add_u32 s52, s6, 0x1200000
    s_addc_u32 s53, s7, 0
    s_mov_b32 s54, 155648
    s_mov_b32 s55, 0x00020000
    s_mov_b32 s56, s50
    s_mov_b32 s57, s51
    s_mov_b32 s58, 256
    s_mov_b32 s59, 0x00020000
    buffer_load_dwordx2 v[18:19], v12, s[56:59], 0 offen sc1
    buffer_load_dword v16, v11, s[20:23], 0 offen
    s_waitcnt vmcnt(10)
    s_barrier
    s_waitcnt vmcnt(2)
    s_barrier
    s_barrier
    s_mov_b32 s16, s48
    s_mov_b32 s17, s49
    s_mov_b32 s18, 2211840
    s_mov_b32 s19, 0x00020000
    s_waitcnt vmcnt(1)
    s_mov_b32 s3, 0
Lcc1:
    v_readfirstlane_b32 s49, v18
    s_add_u32 s3, s3, 1
    s_cmp_lg_u32 s49, 0
    s_cbranch_scc1 Lcd1
    s_cmp_ge_u32 s3, 131072
    s_cbranch_scc1 Lcd1
    buffer_load_dwordx2 v[18:19], v12, s[56:59], 0 offen sc1
    s_waitcnt vmcnt(0)
    s_branch Lcc1
Lcd1:
    v_readfirstlane_b32 s98, v18
    v_readfirstlane_b32 s99, v19
    s_cmp_lg_u32 s32, 27
    s_cbranch_scc1 Lg1_nc3
    s_getpc_b64 s[36:37]
Lcpf2:
    s_add_u32 s36, s36, Lg2c-Lcpf2
    s_addc_u32 s37, s37, (Lg2c-Lcpf2)>>32
    v_lshlrev_b32 v14, 7, v0
    s_lshl_b32 s38, s33, 13
    v_add_u32 v14, s38, v14
    v_min_u32 v14, Lk1_end-Lg2c, v14
    v_mov_b32 v15, s37
    v_add_co_u32 v14, vcc, s36, v14
    s_nop 1
    v_addc_co_u32 v15, vcc, 0, v15, vcc
    global_load_dword v23, v[14:15], off
Lg1_nc3:
    s_mov_b32 s51, 0
    s_mov_b32 s42, 0
    s_cmp_ge_u32 s32, 20
    s_cbranch_scc1 Lp2
    s_lshr_b32 s30, s32, 2
    s_and_b32 s50, s31, 1
    s_lshl_b32 s34, s29, 2
    s_add_u32 s34, s34, s33
    s_mul_i32 s34, s34, 110592
    v_lshl_add_u32 v4, v0, 4, s34
    v_lshrrev_b32 v3, 4, v0
    v_and_b32 v2, 15, v0
    v_lshlrev_b32 v5, 2, v3
    v_xor_b32 v2, v2, v5
    s_and_b32 s34, s33, 1
    s_lshl_b32 s34, s34, 5
    v_add_u32 v8, s34, v3
    v_mul_u32_u24 v8, 1280, v8
    s_lshl_b32 s34, s30, 8
    v_lshl_add_u32 v10, v2, 4, v8
    v_add_u32 v10, s34, v10
    s_lshl_b32 s34, s29, 1
    s_lshr_b32 s35, s33, 1
    s_add_u32 s34, s34, s35
    s_lshl_b32 s34, s29, 12
    v_lshl_add_u32 v13, v0, 7, s34
    s_mul_i32 s44, s50, 57344
    s_mul_i32 s45, s50, 1146880
    s_mul_i32 s34, s35, 81920
    s_add_u32 s45, s45, s34
    s_mov_b32 s12, s6
    s_mov_b32 s13, s7
    s_mov_b32 s14, 7077888
    s_mov_b32 s15, 0x00020000
    s_mov_b32 s46, s30
    s_mul_i32 s42, s46, 163840
    s_add_u32 s42, s42, s45
    s_add_u32 m0, s40, 16384
    s_nop 0
    buffer_load_dwordx4 v10, s[16:19], s42 offen lds
    s_add_u32 s42, s42, 5120
    s_add_u32 m0, s40, 17408
    s_nop 0
    buffer_load_dwordx4 v10, s[16:19], s42 offen lds
    s_add_u32 s42, s42, 5120
    s_add_u32 m0, s40, 18432
    s_nop 0
    buffer_load_dwordx4 v10, s[16:19], s42 offen lds
    s_add_u32 s42, s42, 5120
    s_add_u32 m0, s40, 19456
    s_nop 0
    buffer_load_dwordx4 v10, s[16:19], s42 offen lds
    s_mov_b32 s46, s30
    s_mul_i32 s42, s46, 163840
    s_add_u32 s42, s42, s45
    s_add_u32 s42, s42, 20480
    s_add_u32 m0, s40, 49152
    s_nop 0
    buffer_load_dwordx4 v10, s[16:19], s42 offen lds
    s_add_u32 s42, s42, 5120
    s_add_u32 m0, s40, 50176
    s_nop 0
    buffer_load_dwordx4 v10, s[16:19], s42 offen lds
    s_add_u32 s42, s42, 5120
    s_add_u32 m0, s40, 51200
    s_nop 0
    buffer_load_dwordx4 v10, s[16:19], s42 offen lds
    s_add_u32 s42, s42, 5120
    s_add_u32 m0, s40, 52224
    s_nop 0
    buffer_load_dwordx4 v10, s[16:19], s42 offen lds
    s_cmp_eq_u32 s50, 0
    s_mov_b32 s36, 0x555
    s_cselect_b32 s36, s36, 0x1554000
    s_mov_b32 s37, 0
    s_barrier
    s_waitcnt vmcnt(0)
    s_cmp_lg_u32 s28, 4
    s_cbranch_scc1 Lg2_n1
    s_mov_b64 exec, s[36:37]
    v_mov_b32 v20, 0
    v_mov_b32 v21, 0
    buffer_atomic_add_x2 v[20:21], v13, s[52:55], 0 offen sc0 sc1
    s_mov_b64 exec, -1
Lg2_n1:
    s_add_u32 s46, s30, 1
    s_cmp_ge_u32 s46, 6
    s_cselect_b32 s47, 6, 0
    s_sub_u32 s46, s46, s47
    s_mul_i32 s42, s46, 163840
    s_add_u32 s42, s42, s45
    s_add_u32 m0, s40, 81920
    s_nop 0
    buffer_load_dwordx4 v10, s[16:19], s42 offen lds
    s_add_u32 s42, s42, 5120
    s_add_u32 m0, s40, 82944
    s_nop 0
    buffer_load_dwordx4 v10, s[16:19], s42 offen lds
    s_add_u32 s42, s42, 5120
    s_add_u32 m0, s40, 83968
    s_nop 0
    buffer_load_dwordx4 v10, s[16:19], s42 offen lds
    s_add_u32 s42, s42, 5120
    s_add_u32 m0, s40, 84992
    s_nop 0
    buffer_load_dwordx4 v10, s[16:19], s42 offen lds
    s_add_u32 s46, s30, 2
    s_cmp_ge_u32 s46, 6
    s_cselect_b32 s47, 6, 0
    s_sub_u32 s46, s46, s47
    s_mul_i32 s42, s46, 163840
    s_add_u32 s42, s42, s45
    s_add_u32 m0, s40, 114688
    s_nop 0
    buffer_load_dwordx4 v10, s[16:19], s42 offen lds
    s_add_u32 s42, s42, 5120
    s_add_u32 m0, s40, 115712
    s_nop 0
    buffer_load_dwordx4 v10, s[16:19], s42 offen lds
    s_add_u32 s42, s42, 5120
    s_add_u32 m0, s40, 116736
    s_nop 0
    buffer_load_dwordx4 v10, s[16:19], s42 offen lds
    s_add_u32 s42, s42, 5120
    s_add_u32 m0, s40, 117760
    s_nop 0
    buffer_load_dwordx4 v10, s[16:19], s42 offen lds
    s_barrier
    s_cmp_lg_u32 s28, 4
    s_cbranch_scc1 Lg2_n2
    s_waitcnt vmcnt(8)
    s_mov_b32 s3, 0
Len2:
    v_cmp_eq_u64 vcc, s[98:99], v[20:21]
    s_add_u32 s3, s3, 1
    s_nop 0
    s_andn2_b64 s[36:37], s[36:37], vcc
    s_cbranch_scc0 Leo2
    s_cmp_ge_u32 s3, 131072
    s_cbranch_scc1 Leo2
    s_mov_b64 exec, s[36:37]
    v_mov_b32 v20, 0
    v_mov_b32 v21, 0
    buffer_atomic_add_x2 v[20:21], v13, s[52:55], 0 offen sc0 sc1
    s_mov_b64 exec, -1
    s_waitcnt vmcnt(0)
    s_branch Len2
Leo2:
Lg2_n2:
    s_barrier
    s_add_u32 s46, s30, 1
    s_cmp_ge_u32 s46, 6
    s_cselect_b32 s47, 6, 0
    s_sub_u32 s46, s46, s47
    s_lshl_b32 s41, s46, 13
    s_add_u32 s41, s41, s44
    s_add_u32 s43, s41, 2048
    s_add_u32 m0, s40, 65536
    s_nop 0
    buffer_load_dwordx4 v4, s[12:15], s41 offen offset:0 sc1 lds
    buffer_load_dwordx4 v4, s[12:15], s41 offen offset:1024 sc1 lds
    buffer_load_dwordx4 v4, s[12:15], s43 offen offset:2048 sc1 lds
    buffer_load_dwordx4 v4, s[12:15], s43 offen offset:3072 sc1 lds
    s_add_u32 s46, s30, 2
    s_cmp_ge_u32 s46, 6
    s_cselect_b32 s47, 6, 0
    s_sub_u32 s46, s46, s47
    s_lshl_b32 s41, s46, 13
    s_add_u32 s41, s41, s44
    s_add_u32 s43, s41, 2048
    s_add_u32 m0, s40, 98304
    s_nop 0
    buffer_load_dwordx4 v4, s[12:15], s41 offen offset:0 sc1 lds
    buffer_load_dwordx4 v4, s[12:15], s41 offen offset:1024 sc1 lds
    buffer_load_dwordx4 v4, s[12:15], s43 offen offset:2048 sc1 lds
    buffer_load_dwordx4 v4, s[12:15], s43 offen offset:3072 sc1 lds
    s_waitcnt vmcnt(4)
    s_barrier
    s_add_u32 s46, s30, 3
    s_cmp_ge_u32 s46, 6
    s_cselect_b32 s47, 6, 0
    s_sub_u32 s46, s46, s47
    s_lshl_b32 s41, s46, 13
    s_add_u32 s41, s41, s44
    s_add_u32 s43, s41, 2048
    s_add_u32 m0, s40, 0
    s_nop 0
    buffer_load_dwordx4 v4, s[12:15], s41 offen offset:0 sc1 lds
    buffer_load_dwordx4 v4, s[12:15], s41 offen offset:1024 sc1 lds
    buffer_load_dwordx4 v4, s[12:15], s43 offen offset:2048 sc1 lds
    buffer_load_dwordx4 v4, s[12:15], s43 offen offset:3072 sc1 lds
    s_add_u32 s46, s30, 3
    s_cmp_ge_u32 s46, 6
    s_cselect_b32 s47, 6, 0
    s_sub_u32 s46, s46, s47
    s_mul_i32 s42, s46, 163840
    s_add_u32 s42, s42, s45
    s_add_u32 m0, s40, 16384
    s_nop 0
    buffer_load_dwordx4 v10, s[16:19], s42 offen lds
    s_add_u32 s42, s42, 5120
    s_add_u32 m0, s40, 17408
    s_nop 0
    buffer_load_dwordx4 v10, s[16:19], s42 offen lds
    s_add_u32 s42, s42, 5120
    s_add_u32 m0, s40, 18432
    s_nop 0
    buffer_load_dwordx4 v10, s[16:19], s42 offen lds
    s_add_u32 s42, s42, 5120
    s_add_u32 m0, s40, 19456
    s_nop 0
    buffer_load_dwordx4 v10, s[16:19], s42 offen lds
    s_waitcnt vmcnt(8)
    s_barrier
    s_cmp_eq_u32 s50, 0
    s_mov_b32 s36, 0x3aaa
    s_cselect_b32 s36, s36, 0xeaaa000
    s_mov_b32 s37, 0
    s_cmp_lg_u32 s28, 4
    s_cbranch_scc1 Lg2_n3
    s_mov_b64 exec, s[36:37]
    v_mov_b32 v20, 0
    v_mov_b32 v21, 0
    buffer_atomic_add_x2 v[20:21], v13, s[52:55], 0 offen sc0 sc1
    s_mov_b64 exec, -1
Lg2_n3:
    s_add_u32 s46, s30, 4
    s_cmp_ge_u32 s46, 6
    s_cselect_b32 s47, 6, 0
    s_sub_u32 s46, s46, s47
    s_lshl_b32 s41, s46, 13
    s_add_u32 s41, s41, s44
    s_add_u32 s43, s41, 2048
    s_add_u32 m0, s40, 32768
    s_nop 0
    buffer_load_dwordx4 v4, s[12:15], s41 offen offset:0 sc1 lds
    buffer_load_dwordx4 v4, s[12:15], s41 offen offset:1024 sc1 lds
    buffer_load_dwordx4 v4, s[12:15], s43 offen offset:2048 sc1 lds
    buffer_load_dwordx4 v4, s[12:15], s43 offen offset:3072 sc1 lds
    s_add_u32 s46, s30, 4
    s_cmp_ge_u32 s46, 6
    s_cselect_b32 s47, 6, 0
    s_sub_u32 s46, s46, s47
    s_mul_i32 s42, s46, 163840
    s_add_u32 s42, s42, s45
    s_add_u32 m0, s40, 49152
    s_nop 0
    buffer_load_dwordx4 v10, s[16:19], s42 offen lds
    s_add_u32 s42, s42, 5120
    s_add_u32 m0, s40, 50176
    s_nop 0
    buffer_load_dwordx4 v10, s[16:19], s42 offen lds
    s_add_u32 s42, s42, 5120
    s_add_u32 m0, s40, 51200
    s_nop 0
    buffer_load_dwordx4 v10, s[16:19], s42 offen lds
    s_add_u32 s42, s42, 5120
    s_add_u32 m0, s40, 52224
    s_nop 0
    buffer_load_dwordx4 v10, s[16:19], s42 offen lds
    s_waitcnt vmcnt(9)
    s_cmp_eq_u32 s28, 4
    s_cbranch_scc1 Lg2_w4
    s_waitcnt vmcnt(8)
Lg2_w4:
    s_barrier
    s_add_u32 s46, s30, 5
    s_cmp_ge_u32 s46, 6
    s_cselect_b32 s47, 6, 0
    s_sub_u32 s46, s46, s47
    s_lshl_b32 s41, s46, 13
    s_add_u32 s41, s41, s44
    s_add_u32 s43, s41, 2048
    s_add_u32 m0, s40, 65536
    s_nop 0
    buffer_load_dwordx4 v4, s[12:15], s41 offen offset:0 sc1 lds
    buffer_load_dwordx4 v4, s[12:15], s41 offen offset:1024 sc1 lds
    buffer_load_dwordx4 v4, s[12:15], s43 offen offset:2048 sc1 lds
    buffer_load_dwordx4 v4, s[12:15], s43 offen offset:3072 sc1 lds
    s_add_u32 s46, s30, 5
    s_cmp_ge_u32 s46, 6
    s_cselect_b32 s47, 6, 0
    s_sub_u32 s46, s46, s47
    s_mul_i32 s42, s46, 163840
    s_add_u32 s42, s42, s45
    s_add_u32 m0, s40, 81920
    s_nop 0
    buffer_load_dwordx4 v10, s[16:19], s42 offen lds
    s_add_u32 s42, s42, 5120
    s_add_u32 m0, s40, 82944
    s_nop 0
    buffer_load_dwordx4 v10, s[16:19], s42 offen lds
    s_add_u32 s42, s42, 5120
    s_add_u32 m0, s40, 83968
    s_nop 0
    buffer_load_dwordx4 v10, s[16:19], s42 offen lds
    s_add_u32 s42, s42, 5120
    s_add_u32 m0, s40, 84992
    s_nop 0
    buffer_load_dwordx4 v10, s[16:19], s42 offen lds
    s_waitcnt vmcnt(8)
    s_cmp_lg_u32 s28, 4
    s_cbranch_scc1 Lg2_n4
    s_mov_b32 s3, 0
Len3:
    v_cmp_eq_u64 vcc, s[98:99], v[20:21]
    s_add_u32 s3, s3, 1
    s_nop 0
    s_andn2_b64 s[36:37], s[36:37], vcc
    s_cbranch_scc0 Leo3
    s_cmp_ge_u32 s3, 131072
    s_cbranch_scc1 Leo3
    s_mov_b64 exec, s[36:37]
    v_mov_b32 v20, 0
    v_mov_b32 v21, 0
    buffer_atomic_add_x2 v[20:21], v13, s[52:55], 0 offen sc0 sc1
    s_mov_b64 exec, -1
    s_waitcnt vmcnt(0)
    s_branch Len3
Leo3:
Lg2_n4:
    s_barrier
    s_mov_b32 s46, 6
    s_lshl_b32 s41, s46, 13
    s_add_u32 s41, s41, s44
    s_add_u32 s43, s41, 2048
    s_cmp_eq_u32 s50, 0
    s_cselect_b32 s43, s43, s41
    s_add_u32 m0, s40, 98304
    s_nop 0
    buffer_load_dwordx4 v4, s[12:15], s41 offen offset:0 sc1 lds
    buffer_load_dwordx4 v4, s[12:15], s41 offen offset:1024 sc1 lds
    buffer_load_dwordx4 v4, s[12:15], s43 offen offset:2048 sc1 lds
    buffer_load_dwordx4 v4, s[12:15], s43 offen offset:3072 sc1 lds
    s_mov_b32 s46, 6
    s_mul_i32 s42, s46, 163840
    s_add_u32 s42, s42, s45
    s_and_b32 s34, s50, s35
    s_cmp_eq_u32 s34, 1
    s_cselect_b32 s42, 2150400, s42
    s_add_u32 m0, s40, 114688
    s_nop 0
    buffer_load_dwordx4 v10, s[16:19], s42 offen lds
    s_add_u32 s42, s42, 5120
    s_add_u32 m0, s40, 115712
    s_nop 0
    buffer_load_dwordx4 v10, s[16:19], s42 offen lds
    s_add_u32 s42, s42, 5120
    s_add_u32 m0, s40, 116736
    s_nop 0
    buffer_load_dwordx4 v10, s[16:19], s42 offen lds
    s_add_u32 s42, s42, 5120
    s_add_u32 m0, s40, 117760
    s_nop 0
    buffer_load_dwordx4 v10, s[16:19], s42 offen lds
    s_waitcnt vmcnt(8)
    s_barrier
    s_add_u32 s46, s30, 1
    s_cmp_ge_u32 s46, 6
    s_cselect_b32 s47, 6, 0
    s_sub_u32 s46, s46, s47
    s_lshl_b32 s41, s46, 13
    s_add_u32 s41, s41, s44
    s_add_u32 s41, s41, 2048
    s_add_u32 s43, s41, 2048
    s_add_u32 m0, s40, 0
    s_nop 0
    buffer_load_dwordx4 v4, s[12:15], s41 offen offset:0 sc1 lds
    buffer_load_dwordx4 v4, s[12:15], s41 offen offset:1024 sc1 lds
    buffer_load_dwordx4 v4, s[12:15], s43 offen offset:2048 sc1 lds
    buffer_load_dwordx4 v4, s[12:15], s43 offen offset:3072 sc1 lds
    s_add_u32 s46, s30, 1
    s_cmp_ge_u32 s46, 6
    s_cselect_b32 s47, 6, 0
    s_sub_u32 s46, s46, s47
    s_mul_i32 s42, s46, 163840
    s_add_u32 s42, s42, s45
    s_add_u32 s42, s42, 20480
    s_add_u32 m0, s40, 16384
    s_nop 0
    buffer_load_dwordx4 v10, s[16:19], s42 offen lds
    s_add_u32 s42, s42, 5120
    s_add_u32 m0, s40, 17408
    s_nop 0
    buffer_load_dwordx4 v10, s[16:19], s42 offen lds
    s_add_u32 s42, s42, 5120
    s_add_u32 m0, s40, 18432
    s_nop 0
    buffer_load_dwordx4 v10, s[16:19], s42 offen lds
    s_add_u32 s42, s42, 5120
    s_add_u32 m0, s40, 19456
    s_nop 0
    buffer_load_dwordx4 v10, s[16:19], s42 offen lds
    s_waitcnt vmcnt(8)
    s_barrier
    s_add_u32 s46, s30, 2
    s_cmp_ge_u32 s46, 6
    s_cselect_b32 s47, 6, 0
    s_sub_u32 s46, s46, s47
    s_lshl_b32 s41, s46, 13
    s_add_u32 s41, s41, s44
    s_add_u32 s41, s41, 2048
    s_add_u32 s43, s41, 2048
    s_add_u32 m0, s40, 32768
    s_nop 0
    buffer_load_dwordx4 v4, s[12:15], s41 offen offset:0 sc1 lds
    buffer_load_dwordx4 v4, s[12:15], s41 offen offset:1024 sc1 lds
    buffer_load_dwordx4 v4, s[12:15], s43 offen offset:2048 sc1 lds
    buffer_load_dwordx4 v4, s[12:15], s43 offen offset:3072 sc1 lds
    s_add_u32 s46, s30, 2
    s_cmp_ge_u32 s46, 6
    s_cselect_b32 s47, 6, 0
    s_sub_u32 s46, s46, s47
    s_mul_i32 s42, s46, 163840
    s_add_u32 s42, s42, s45
    s_add_u32 s42, s42, 20480
    s_add_u32 m0, s40, 49152
    s_nop 0
    buffer_load_dwordx4 v10, s[16:19], s42 offen lds
    s_add_u32 s42, s42, 5120
    s_add_u32 m0, s40, 50176
    s_nop 0
    buffer_load_dwordx4 v10, s[16:19], s42 offen lds
    s_add_u32 s42, s42, 5120
    s_add_u32 m0, s40, 51200
    s_nop 0
    buffer_load_dwordx4 v10, s[16:19], s42 offen lds
    s_add_u32 s42, s42, 5120
    s_add_u32 m0, s40, 52224
    s_nop 0
    buffer_load_dwordx4 v10, s[16:19], s42 offen lds
    s_waitcnt vmcnt(8)
    s_barrier
    s_add_u32 s46, s30, 3
    s_cmp_ge_u32 s46, 6
    s_cselect_b32 s47, 6, 0
    s_sub_u32 s46, s46, s47
    s_lshl_b32 s41, s46, 13
    s_add_u32 s41, s41, s44
    s_add_u32 s41, s41, 2048
    s_add_u32 s43, s41, 2048
    s_add_u32 m0, s40, 65536
    s_nop 0
    buffer_load_dwordx4 v4, s[12:15], s41 offen offset:0 sc1 lds
    buffer_load_dwordx4 v4, s[12:15], s41 offen offset:1024 sc1 lds
    buffer_load_dwordx4 v4, s[12:15], s43 offen offset:2048 sc1 lds
    buffer_load_dwordx4 v4, s[12:15], s43 offen offset:3072 sc1 lds
    s_add_u32 s46, s30, 3
    s_cmp_ge_u32 s46, 6
    s_cselect_b32 s47, 6, 0
    s_sub_u32 s46, s46, s47
    s_mul_i32 s42, s46, 163840
    s_add_u32 s42, s42, s45
    s_add_u32 s42, s42, 20480
    s_add_u32 m0, s40, 81920
    s_nop 0
    buffer_load_dwordx4 v10, s[16:19], s42 offen lds
    s_add_u32 s42, s42, 5120
    s_add_u32 m0, s40, 82944
    s_nop 0
    buffer_load_dwordx4 v10, s[16:19], s42 offen lds
    s_add_u32 s42, s42, 5120
    s_add_u32 m0, s40, 83968
    s_nop 0
    buffer_load_dwordx4 v10, s[16:19], s42 offen lds
    s_add_u32 s42, s42, 5120
    s_add_u32 m0, s40, 84992
    s_nop 0
    buffer_load_dwordx4 v10, s[16:19], s42 offen lds
    s_waitcnt vmcnt(8)
    s_barrier
    s_add_u32 s46, s30, 4
    s_cmp_ge_u32 s46, 6
    s_cselect_b32 s47, 6, 0
    s_sub_u32 s46, s46, s47
    s_lshl_b32 s41, s46, 13
    s_add_u32 s41, s41, s44
    s_add_u32 s41, s41, 2048
    s_add_u32 s43, s41, 2048
    s_add_u32 m0, s40, 98304
    s_nop 0
    buffer_load_dwordx4 v4, s[12:15], s41 offen offset:0 sc1 lds
    buffer_load_dwordx4 v4, s[12:15], s41 offen offset:1024 sc1 lds
    buffer_load_dwordx4 v4, s[12:15], s43 offen offset:2048 sc1 lds
    buffer_load_dwordx4 v4, s[12:15], s43 offen offset:3072 sc1 lds
    s_add_u32 s46, s30, 4
    s_cmp_ge_u32 s46, 6
    s_cselect_b32 s47, 6, 0
    s_sub_u32 s46, s46, s47
    s_mul_i32 s42, s46, 163840
    s_add_u32 s42, s42, s45
    s_add_u32 s42, s42, 20480
    s_add_u32 m0, s40, 114688
    s_nop 0
    buffer_load_dwordx4 v10, s[16:19], s42 offen lds
    s_add_u32 s42, s42, 5120
    s_add_u32 m0, s40, 115712
    s_nop 0
    buffer_load_dwordx4 v10, s[16:19], s42 offen lds
    s_add_u32 s42, s42, 5120
    s_add_u32 m0, s40, 116736
    s_nop 0
    buffer_load_dwordx4 v10, s[16:19], s42 offen lds
    s_add_u32 s42, s42, 5120
    s_add_u32 m0, s40, 117760
    s_nop 0
    buffer_load_dwordx4 v10, s[16:19], s42 offen lds
    s_waitcnt vmcnt(8)
    s_barrier
    s_add_u32 s46, s30, 5
    s_cmp_ge_u32 s46, 6
    s_cselect_b32 s47, 6, 0
    s_sub_u32 s46, s46, s47
    s_lshl_b32 s41, s46, 13
    s_add_u32 s41, s41, s44
    s_add_u32 s41, s41, 2048
    s_add_u32 s43, s41, 2048
    s_add_u32 m0, s40, 0
    s_nop 0
    buffer_load_dwordx4 v4, s[12:15], s41 offen offset:0 sc1 lds
    buffer_load_dwordx4 v4, s[12:15], s41 offen offset:1024 sc1 lds
    buffer_load_dwordx4 v4, s[12:15], s43 offen offset:2048 sc1 lds
    buffer_load_dwordx4 v4, s[12:15], s43 offen offset:3072 sc1 lds
    s_add_u32 s46, s30, 5
    s_cmp_ge_u32 s46, 6
    s_cselect_b32 s47, 6, 0
    s_sub_u32 s46, s46, s47
    s_mul_i32 s42, s46, 163840
    s_add_u32 s42, s42, s45
    s_add_u32 s42, s42, 20480
    s_add_u32 m0, s40, 16384
    s_nop 0
    buffer_load_dwordx4 v10, s[16:19], s42 offen lds
    s_add_u32 s42, s42, 5120
    s_add_u32 m0, s40, 17408
    s_nop 0
    buffer_load_dwordx4 v10, s[16:19], s42 offen lds
    s_add_u32 s42, s42, 5120
    s_add_u32 m0, s40, 18432
    s_nop 0
    buffer_load_dwordx4 v10, s[16:19], s42 offen lds
    s_add_u32 s42, s42, 5120
    s_add_u32 m0, s40, 19456
    s_nop 0
    buffer_load_dwordx4 v10, s[16:19], s42 offen lds
    s_waitcnt vmcnt(8)
    s_barrier
    s_cmp_eq_u32 s50, 0
    s_mov_b32 s41, 51200
    s_cselect_b32 s41, s41, 55296
    s_add_u32 m0, s40, 32768
    s_nop 0
    buffer_load_dwordx4 v4, s[12:15], s41 offen offset:0 sc1 lds
    buffer_load_dwordx4 v4, s[12:15], s41 offen offset:1024 sc1 lds
    s_cmp_eq_u32 s50, 0
    s_mov_b32 s42, 1003520
    s_cselect_b32 s42, s42, 1085440
    s_cmp_eq_u32 s35, 0
    s_cselect_b32 s18, s18, 0
    s_add_u32 m0, s40, 49152
    s_nop 0
    buffer_load_dwordx4 v10, s[16:19], s42 offen lds
    s_add_u32 s42, s42, 5120
    s_add_u32 m0, s40, 50176
    s_nop 0
    buffer_load_dwordx4 v10, s[16:19], s42 offen lds
    s_add_u32 s42, s42, 5120
    s_add_u32 m0, s40, 51200
    s_nop 0
    buffer_load_dwordx4 v10, s[16:19], s42 offen lds
    s_add_u32 s42, s42, 5120
    s_add_u32 m0, s40, 52224
    s_nop 0
    buffer_load_dwordx4 v10, s[16:19], s42 offen lds
    s_waitcnt vmcnt(6)
    s_barrier
    s_waitcnt vmcnt(0)
    s_barrier
    s_branch Lp3
Lg1c:
    s_and_b32 s33, s28, 1
    s_lshr_b32 s34, s28, 1
    v_and_b32 v1, 31, v0
    v_lshrrev_b32 v2, 5, v0
    s_lshl_b32 s35, s30, 7
    s_lshl_b32 s40, s33, 6
    s_add_u32 s35, s35, s40
    s_lshl_b32 s40, s34, 5
    s_add_u32 s35, s35, s40
    v_add_lshl_u32 v9, v1, s35, 1
    v_mov_b32 v221, 0
    s_lshl_b32 s35, s34, 13
    s_lshl_b32 s40, s33, 12
    s_add_u32 s35, s35, s40
    v_lshl_add_u32 v3, v1, 7, s35
    v_bfe_u32 v4, v0, 1, 3
    v_xor_b32 v4, v4, v2
    v_xor_b32 v5, 0, v4
    v_lshl_add_u32 v208, v5, 4, v3
    v_xor_b32 v209, 0x1000, v208
    v_xor_b32 v5, 2, v4
    v_lshl_add_u32 v210, v5, 4, v3
    v_xor_b32 v211, 0x1000, v210
    v_xor_b32 v5, 4, v4
    v_lshl_add_u32 v212, v5, 4, v3
    v_xor_b32 v213, 0x1000, v212
    v_xor_b32 v5, 6, v4
    v_lshl_add_u32 v214, v5, 4, v3
    v_xor_b32 v215, 0x1000, v214
    v_bfe_u32 v4, v0, 2, 2
    v_lshl_add_u32 v5, v2, 3, v4
    v_lshlrev_b32 v5, 8, v5
    v_bfe_u32 v6, v0, 4, 1
    v_lshl_add_u32 v5, v6, 5, v5
    v_and_b32 v6, 3, v0
    v_lshl_add_u32 v5, v6, 3, v5
    s_lshl_b32 s35, s33, 1
    s_add_u32 s35, s35, s34
    v_xor_b32 v6, s35, v4
    v_lshl_add_u32 v216, v6, 6, v5
    v_xor_b32 v217, 64, v216
    v_mov_b32 v218, 0
    v_mov_b32 v219, 0
    v_mov_b32 v220, 0
    s_mov_b32 s41, 0x3f803f80
    s_waitcnt lgkmcnt(0)
    s_mov_b32 s20, s10
    s_mov_b32 s21, s11
    s_mov_b32 s22, 3456
    s_mov_b32 s23, 0x00020000
    s_mov_b32 s24, s6
    s_mov_b32 s25, s7
    s_mov_b32 s26, 7077888
    s_mov_b32 s27, 0x00020000
    buffer_load_short_d16_hi v221, v9, s[20:23], 0 offen
    s_mov_b32 s16, s36
    s_mov_b32 s17, s37
    s_mov_b32 s18, 1280
    s_mov_b32 s19, 0x00020000
    s_lshr_b32 s35, s32, 2
    s_lshl_b32 s35, s35, 8
    s_lshl_b32 s40, s33, 7
    s_add_u32 s35, s35, s40
    s_lshl_b32 s40, s31, 31
    s_or_b32 s35, s35, s40
    v_lshl_add_u32 v9, v1, 1, s35
    buffer_load_ushort v222, v9, s[16:19], 0 offen
    buffer_load_ushort v223, v9, s[16:19], 0 offen offset:64
    s_lshl_b32 s35, s30, 1
    s_add_u32 s35, s35, s33
    s_lshl_b32 s40, s29, 2
    s_lshl_b32 s42, s34, 1
    s_add_u32 s40, s40, s42
    s_xor_b32 s42, s33, 0
    s_add_u32 s40, s40, s42
    s_mulk_i32 s40, 108
    s_lshl_b32 s42, s35, 2
    s_add_u32 s40, s40, s42
    s_xor_b32 s42, s34, 0
    s_add_u32 s40, s40, s42
    s_lshl_b32 s44, s40, 10
    s_lshl_b32 s40, s29, 2
    s_lshl_b32 s42, s34, 1
    s_add_u32 s40, s40, s42
    s_xor_b32 s42, s33, 1
    s_add_u32 s40, s40, s42
    s_mulk_i32 s40, 108
    s_lshl_b32 s42, s35, 2
    s_add_u32 s40, s40, s42
    s_xor_b32 s42, s34, 0
    s_add_u32 s40, s40, s42
    s_lshl_b32 s45, s40, 10
    s_lshl_b32 s40, s29, 2
    s_lshl_b32 s42, s34, 1
    s_add_u32 s40, s40, s42
    s_xor_b32 s42, s33, 0
    s_add_u32 s40, s40, s42
    s_mulk_i32 s40, 108
    s_lshl_b32 s42, s35, 2
    s_add_u32 s40, s40, s42
    s_xor_b32 s42, s34, 1
    s_add_u32 s40, s40, s42
    s_lshl_b32 s46, s40, 10
    s_lshl_b32 s40, s29, 2
    s_lshl_b32 s42, s34, 1
    s_add_u32 s40, s40, s42
    s_xor_b32 s42, s33, 1
    s_add_u32 s40, s40, s42
    s_mulk_i32 s40, 108
    s_lshl_b32 s42, s35, 2
    s_add_u32 s40, s40, s42
    s_xor_b32 s42, s34, 1
    s_add_u32 s40, s40, s42
    s_lshl_b32 s47, s40, 10
    s_lshl_b32 s42, s34, 9
    s_lshl_b32 s40, s33, 8
    s_add_u32 s42, s42, s40
    s_add_u32 s42, s42, 65536
    v_lshl_add_u32 v7, v1, 3, s42
    s_lshl_b32 s42, s33, 9
    s_lshl_b32 s40, s34, 8
    s_add_u32 s42, s42, s40
    s_add_u32 s42, s42, 65536
    v_lshl_add_u32 v8, v1, 3, s42
    v_lshlrev_b32 v9, 4, v0
    v_mov_b32 v226, 0
    v_mov_b32 v227, 0
    v_mov_b32 v230, 0
    v_mov_b32 v231, 0
    v_mov_b32 v234, 0
    v_mov_b32 v235, 0
    v_mov_b32 v238, 0
    v_mov_b32 v239, 0
    s_add_u32 s52, s6, 0x1200000
    s_addc_u32 s53, s7, 0
    s_mov_b32 s54, 155648
    s_mov_b32 s55, 0x00020000
    s_mov_b32 s56, s50
    s_mov_b32 s57, s51
    s_mov_b32 s58, 256
    s_mov_b32 s59, 0x00020000
    s_lshl_b32 s48, s29, 12
    s_lshl_b32 s40, s30, 8
    s_add_u32 s48, s48, s40
    v_mov_b32 v10, 0
    v_lshlrev_b32 v11, 3, v0
    s_lshl_b32 s40, s2, 3
    s_add_u32 s40, s40, s28
    s_cmp_lg_u32 s40, 1737
    s_cbranch_scc1 Lg1_ncl
    v_mov_b32 v12, 0
    v_mov_b32 v13, 0
    v_mov_b32 v14, 0
    v_mov_b32 v15, 0
    s_mov_b32 s40, 102400
Lg1_cl:
    buffer_store_dwordx4 v[12:15], v9, s[52:55], s40 offen sc1
    s_add_u32 s40, s40, 1024
    s_cmp_lt_u32 s40, 135168
    s_cbranch_scc1 Lg1_cl
    s_memrealtime s[36:37]
    s_waitcnt vmcnt(0) lgkmcnt(0)
    s_or_b32 s38, s36, 1
    v_mov_b32 v12, s38
    v_mov_b32 v13, s37
    s_mov_b64 exec, 1
    buffer_store_dwordx2 v[12:13], v10, s[56:59], 0 offen sc1
    s_mov_b64 exec, -1
Lg1_ncl:
    s_lshl_b32 s40, s34, 13
    v_lshl_add_u32 v248, v0, 4, s40
    v_bfe_u32 v4, v0, 2, 2
    v_lshl_add_u32 v5, v2, 2, v4
    v_lshlrev_b32 v5, 8, v5
    v_bfe_u32 v6, v0, 4, 1
    v_lshl_add_u32 v5, v6, 5, v5
    v_and_b32 v6, 3, v0
    v_lshl_add_u32 v5, v6, 3, v5
    s_lshl_b32 s40, s33, 1
    v_xor_b32 v6, s40, v4
    v_lshl_add_u32 v249, v6, 6, v5
    v_xor_b32 v250, 64, v249
    s_add_u32 s20, s6, 0xd00000
    s_addc_u32 s21, s7, 0
    s_mov_b32 s22, 5242880
    s_mov_b32 s23, 0x00020000
    v_lshlrev_b32 v5, 9, v2
    v_lshl_add_u32 v251, v1, 3, v5
    s_lshr_b32 s39, s32, 2
    s_and_b32 s50, s31, 1
    s_lshl_b32 s40, s29, 2
    s_lshl_b32 s42, s34, 1
    s_add_u32 s40, s40, s42
    s_mul_i32 s40, s40, 10
    s_lshl_b32 s42, s39, 1
    s_add_u32 s40, s40, s42
    s_add_u32 s40, s40, s33
    s_lshl_b32 s40, s40, 12
    s_mul_i32 s42, s50, 2621440
    s_add_u32 s36, s40, s42
    s_add_u32 s37, s36, 40960
    s_lshl_b32 s40, s34, 13
    s_lshl_b32 s42, s33, 12
    s_add_u32 s40, s40, s42
    s_lshl_b32 s42, s33, 11
    s_add_u32 s40, s40, s42
    s_lshl_b32 s42, s34, 10
    s_add_u32 s40, s40, s42
    v_add_u32 v12, s40, v9
    v_xor_b32 v13, 0x1000, v12
    v_xor_b32 v14, 0x400, v12
    v_xor_b32 v15, 0x1400, v12
    s_barrier
    ds_read_b64_tr_b16 v[88:89], v216 offset:16384
    ds_read_b64_tr_b16 v[90:91], v216 offset:17408
    ds_read_b64_tr_b16 v[92:93], v217 offset:16384
    ds_read_b64_tr_b16 v[94:95], v217 offset:17408
    ds_read_b128 v[80:83], v208 offset:0
    ds_read_b128 v[84:87], v209 offset:0
    ds_read_b64_tr_b16 v[104:105], v216 offset:20480
    ds_read_b64_tr_b16 v[106:107], v216 offset:21504
    ds_read_b64_tr_b16 v[108:109], v217 offset:20480
    ds_read_b64_tr_b16 v[110:111], v217 offset:21504
    ds_read_b128 v[96:99], v210 offset:0
    ds_read_b128 v[100:103], v211 offset:0
    ds_read_b64_tr_b16 v[120:121], v216 offset:24576
    ds_read_b64_tr_b16 v[122:123], v216 offset:25600
    ds_read_b64_tr_b16 v[124:125], v217 offset:24576
    ds_read_b64_tr_b16 v[126:127], v217 offset:25600
    ds_read_b128 v[112:115], v212 offset:0
    ds_read_b128 v[116:119], v213 offset:0
    ds_read_b64_tr_b16 v[136:137], v216 offset:28672
    ds_read_b64_tr_b16 v[138:139], v216 offset:29696
    ds_read_b64_tr_b16 v[140:141], v217 offset:28672
    ds_read_b64_tr_b16 v[142:143], v217 offset:29696
    ds_read_b128 v[128:131], v214 offset:0
    ds_read_b128 v[132:135], v215 offset:0
    s_waitcnt lgkmcnt(0)
    v_mfma_f32_32x32x16_bf16 v[16:31], v[88:91], v[80:83], 0
    v_dot2c_f32_bf16 v218, s41, v80
    v_dot2c_f32_bf16 v219, v80, v80
    v_dot2c_f32_bf16 v220, s41, v88
    v_dot2c_f32_bf16 v218, s41, v81
    v_mfma_f32_32x32x16_bf16 v[32:47], v[88:91], v[84:87], 0
    v_dot2c_f32_bf16 v219, v81, v81
    v_dot2c_f32_bf16 v220, s41, v89
    v_dot2c_f32_bf16 v218, s41, v82
    v_dot2c_f32_bf16 v219, v82, v82
    v_dot2c_f32_bf16 v220, s41, v90
    v_mfma_f32_32x32x16_bf16 v[48:63], v[92:95], v[80:83], 0
    v_dot2c_f32_bf16 v218, s41, v83
    v_dot2c_f32_bf16 v219, v83, v83
    v_dot2c_f32_bf16 v220, s41, v91
    v_dot2c_f32_bf16 v218, s41, v96
    v_dot2c_f32_bf16 v219, v96, v96
    v_mfma_f32_32x32x16_bf16 v[64:79], v[92:95], v[84:87], 0
    v_dot2c_f32_bf16 v220, s41, v104
    v_dot2c_f32_bf16 v218, s41, v97
    v_dot2c_f32_bf16 v219, v97, v97
    v_dot2c_f32_bf16 v220, s41, v105
    v_dot2c_f32_bf16 v218, s41, v98
    v_mfma_f32_32x32x16_bf16 v[16:31], v[104:107], v[96:99], v[16:31]
    v_dot2c_f32_bf16 v219, v98, v98
    v_dot2c_f32_bf16 v220, s41, v106
    v_dot2c_f32_bf16 v218, s41, v99
    v_dot2c_f32_bf16 v219, v99, v99
    v_dot2c_f32_bf16 v220, s41, v107
    v_mfma_f32_32x32x16_bf16 v[32:47], v[104:107], v[100:103], v[32:47]
    v_dot2c_f32_bf16 v218, s41, v112
    v_dot2c_f32_bf16 v219, v112, v112
    v_dot2c_f32_bf16 v220, s41, v120
    v_dot2c_f32_bf16 v218, s41, v113
    v_mfma_f32_32x32x16_bf16 v[48:63], v[108:111], v[96:99], v[48:63]
    v_dot2c_f32_bf16 v219, v113, v113
    v_dot2c_f32_bf16 v220, s41, v121
    v_dot2c_f32_bf16 v218, s41, v114
    v_dot2c_f32_bf16 v219, v114, v114
    v_dot2c_f32_bf16 v220, s41, v122
    v_mfma_f32_32x32x16_bf16 v[64:79], v[108:111], v[100:103], v[64:79]
    v_dot2c_f32_bf16 v218, s41, v115
    v_dot2c_f32_bf16 v219, v115, v115
    v_dot2c_f32_bf16 v220, s41, v123
    v_dot2c_f32_bf16 v218, s41, v128
    v_dot2c_f32_bf16 v219, v128, v128
    v_mfma_f32_32x32x16_bf16 v[16:31], v[120:123], v[112:115], v[16:31]
    v_dot2c_f32_bf16 v220, s41, v136
    v_dot2c_f32_bf16 v218, s41, v129
    v_dot2c_f32_bf16 v219, v129, v129
    v_dot2c_f32_bf16 v220, s41, v137
    v_dot2c_f32_bf16 v218, s41, v130
    v_mfma_f32_32x32x16_bf16 v[32:47], v[120:123], v[116:119], v[32:47]
    v_dot2c_f32_bf16 v219, v130, v130
    v_dot2c_f32_bf16 v220, s41, v138
    v_dot2c_f32_bf16 v218, s41, v131
    v_dot2c_f32_bf16 v219, v131, v131
    v_dot2c_f32_bf16 v220, s41, v139
    s_barrier
    v_mfma_f32_32x32x16_bf16 v[48:63], v[124:127], v[112:115], v[48:63]
    ds_read_b64_tr_b16 v[152:153], v216 offset:49152
    ds_read_b64_tr_b16 v[154:155], v216 offset:50176
    ds_read_b64_tr_b16 v[156:157], v217 offset:49152
    ds_read_b64_tr_b16 v[158:159], v217 offset:50176
    ds_read_b128 v[144:147], v208 offset:32768
    ds_read_b128 v[148:151], v209 offset:32768
    v_mfma_f32_32x32x16_bf16 v[64:79], v[124:127], v[116:119], v[64:79]
    ds_read_b64_tr_b16 v[168:169], v216 offset:53248
    ds_read_b64_tr_b16 v[170:171], v216 offset:54272
    ds_read_b64_tr_b16 v[172:173], v217 offset:53248
    ds_read_b64_tr_b16 v[174:175], v217 offset:54272
    ds_read_b128 v[160:163], v210 offset:32768
    ds_read_b128 v[164:167], v211 offset:32768
    v_mfma_f32_32x32x16_bf16 v[16:31], v[136:139], v[128:131], v[16:31]
    ds_read_b64_tr_b16 v[184:185], v216 offset:57344
    ds_read_b64_tr_b16 v[186:187], v216 offset:58368
    ds_read_b64_tr_b16 v[188:189], v217 offset:57344
    ds_read_b64_tr_b16 v[190:191], v217 offset:58368
    ds_read_b128 v[176:179], v212 offset:32768
    ds_read_b128 v[180:183], v213 offset:32768
    v_mfma_f32_32x32x16_bf16 v[32:47], v[136:139], v[132:135], v[32:47]
    ds_read_b64_tr_b16 v[200:201], v216 offset:61440
    ds_read_b64_tr_b16 v[202:203], v216 offset:62464
    ds_read_b64_tr_b16 v[204:205], v217 offset:61440
    ds_read_b64_tr_b16 v[206:207], v217 offset:62464
    ds_read_b128 v[192:195], v214 offset:32768
    ds_read_b128 v[196:199], v215 offset:32768
    v_mfma_f32_32x32x16_bf16 v[48:63], v[140:143], v[128:131], v[48:63]
    v_mfma_f32_32x32x16_bf16 v[64:79], v[140:143], v[132:135], v[64:79]
    s_waitcnt lgkmcnt(0)
    v_mfma_f32_32x32x16_bf16 v[16:31], v[152:155], v[144:147], v[16:31]
    v_dot2c_f32_bf16 v218, s41, v144
    v_dot2c_f32_bf16 v219, v144, v144
    v_dot2c_f32_bf16 v220, s41, v152
    v_dot2c_f32_bf16 v218, s41, v145
    v_mfma_f32_32x32x16_bf16 v[32:47], v[152:155], v[148:151], v[32:47]
    v_dot2c_f32_bf16 v219, v145, v145
    v_dot2c_f32_bf16 v220, s41, v153
    v_dot2c_f32_bf16 v218, s41, v146
    v_dot2c_f32_bf16 v219, v146, v146
    v_dot2c_f32_bf16 v220, s41, v154
    v_mfma_f32_32x32x16_bf16 v[48:63], v[156:159], v[144:147], v[48:63]
    v_dot2c_f32_bf16 v218, s41, v147
    v_dot2c_f32_bf16 v219, v147, v147
    v_dot2c_f32_bf16 v220, s41, v155
    v_dot2c_f32_bf16 v218, s41, v160
    v_dot2c_f32_bf16 v219, v160, v160
    v_mfma_f32_32x32x16_bf16 v[64:79], v[156:159], v[148:151], v[64:79]
    v_dot2c_f32_bf16 v220, s41, v168
    v_dot2c_f32_bf16 v218, s41, v161
    v_dot2c_f32_bf16 v219, v161, v161
    v_dot2c_f32_bf16 v220, s41, v169
    v_dot2c_f32_bf16 v218, s41, v162
    v_mfma_f32_32x32x16_bf16 v[16:31], v[168:171], v[160:163], v[16:31]
    v_dot2c_f32_bf16 v219, v162, v162
    v_dot2c_f32_bf16 v220, s41, v170
    v_dot2c_f32_bf16 v218, s41, v163
    v_dot2c_f32_bf16 v219, v163, v163
    v_dot2c_f32_bf16 v220, s41, v171
    v_mfma_f32_32x32x16_bf16 v[32:47], v[168:171], v[164:167], v[32:47]
    v_dot2c_f32_bf16 v218, s41, v176
    v_dot2c_f32_bf16 v219, v176, v176
    v_dot2c_f32_bf16 v220, s41, v184
    v_dot2c_f32_bf16 v218, s41, v177
    v_mfma_f32_32x32x16_bf16 v[48:63], v[172:175], v[160:163], v[48:63]
    v_dot2c_f32_bf16 v219, v177, v177
    v_dot2c_f32_bf16 v220, s41, v185
    v_dot2c_f32_bf16 v218, s41, v178
    v_dot2c_f32_bf16 v219, v178, v178
    v_dot2c_f32_bf16 v220, s41, v186
    v_mfma_f32_32x32x16_bf16 v[64:79], v[172:175], v[164:167], v[64:79]
    v_dot2c_f32_bf16 v218, s41, v179
    v_dot2c_f32_bf16 v219, v179, v179
    v_dot2c_f32_bf16 v220, s41, v187
    v_dot2c_f32_bf16 v218, s41, v192
    v_dot2c_f32_bf16 v219, v192, v192
    v_mfma_f32_32x32x16_bf16 v[16:31], v[184:187], v[176:179], v[16:31]
    v_dot2c_f32_bf16 v220, s41, v200
    v_dot2c_f32_bf16 v218, s41, v193
    v_dot2c_f32_bf16 v219, v193, v193
    v_dot2c_f32_bf16 v220, s41, v201
    v_dot2c_f32_bf16 v218, s41, v194
    v_mfma_f32_32x32x16_bf16 v[32:47], v[184:187], v[180:183], v[32:47]
    v_dot2c_f32_bf16 v219, v194, v194
    v_dot2c_f32_bf16 v220, s41, v202
    v_dot2c_f32_bf16 v218, s41, v195
    v_dot2c_f32_bf16 v219, v195, v195
    v_dot2c_f32_bf16 v220, s41, v203
    s_barrier
    v_mfma_f32_32x32x16_bf16 v[48:63], v[188:191], v[176:179], v[48:63]
    v_xor_b32 v208, 0x10000, v208
    v_xor_b32 v209, 0x10000, v209
    v_xor_b32 v210, 0x10000, v210
    v_xor_b32 v211, 0x10000, v211
    v_xor_b32 v212, 0x10000, v212
    v_xor_b32 v213, 0x10000, v213
    v_xor_b32 v214, 0x10000, v214
    v_xor_b32 v215, 0x10000, v215
    v_mfma_f32_32x32x16_bf16 v[64:79], v[188:191], v[180:183], v[64:79]
    v_xor_b32 v216, 0x10000, v216
    v_xor_b32 v217, 0x10000, v217
    ds_read_b64_tr_b16 v[88:89], v216 offset:16384
    ds_read_b64_tr_b16 v[90:91], v216 offset:17408
    ds_read_b64_tr_b16 v[92:93], v217 offset:16384
    ds_read_b64_tr_b16 v[94:95], v217 offset:17408
    ds_read_b128 v[80:83], v208 offset:0
    ds_read_b128 v[84:87], v209 offset:0
    ds_read_b64_tr_b16 v[104:105], v216 offset:20480
    v_mfma_f32_32x32x16_bf16 v[16:31], v[200:203], v[192:195], v[16:31]
    ds_read_b64_tr_b16 v[106:107], v216 offset:21504
    ds_read_b64_tr_b16 v[108:109], v217 offset:20480
    ds_read_b64_tr_b16 v[110:111], v217 offset:21504
    ds_read_b128 v[96:99], v210 offset:0
    ds_read_b128 v[100:103], v211 offset:0
    ds_read_b64_tr_b16 v[120:121], v216 offset:24576
    ds_read_b64_tr_b16 v[122:123], v216 offset:25600
    ds_read_b64_tr_b16 v[124:125], v217 offset:24576
    v_mfma_f32_32x32x16_bf16 v[32:47], v[200:203], v[196:199], v[32:47]
    ds_read_b64_tr_b16 v[126:127], v217 offset:25600
    ds_read_b128 v[112:115], v212 offset:0
    ds_read_b128 v[116:119], v213 offset:0
    ds_read_b64_tr_b16 v[136:137], v216 offset:28672
    ds_read_b64_tr_b16 v[138:139], v216 offset:29696
    ds_read_b64_tr_b16 v[140:141], v217 offset:28672
    ds_read_b64_tr_b16 v[142:143], v217 offset:29696
    ds_read_b128 v[128:131], v214 offset:0
    ds_read_b128 v[132:135], v215 offset:0
    v_mfma_f32_32x32x16_bf16 v[48:63], v[204:207], v[192:195], v[48:63]
    v_mfma_f32_32x32x16_bf16 v[64:79], v[204:207], v[196:199], v[64:79]
    s_waitcnt lgkmcnt(0)
    s_barrier
    v_mfma_f32_32x32x16_bf16 v[16:31], v[88:91], v[80:83], v[16:31]
    ds_read_b64_tr_b16 v[152:153], v216 offset:49152
    v_mfma_f32_32x32x16_bf16 v[32:47], v[88:91], v[84:87], v[32:47]
    ds_read_b64_tr_b16 v[154:155], v216 offset:50176
    ds_read_b64_tr_b16 v[156:157], v217 offset:49152
    v_dot2c_f32_bf16 v218, s41, v80
    v_dot2c_f32_bf16 v219, v80, v80
    v_dot2c_f32_bf16 v220, s41, v88
    v_dot2c_f32_bf16 v218, s41, v81
    v_mfma_f32_32x32x16_bf16 v[48:63], v[92:95], v[80:83], v[48:63]
    ds_read_b64_tr_b16 v[158:159], v217 offset:50176
    ds_read_b128 v[144:147], v208 offset:32768
    ds_read_b128 v[148:151], v209 offset:32768
    v_dot2c_f32_bf16 v219, v81, v81
    v_dot2c_f32_bf16 v220, s41, v89
    v_dot2c_f32_bf16 v218, s41, v82
    v_dot2c_f32_bf16 v219, v82, v82
    v_mfma_f32_32x32x16_bf16 v[64:79], v[92:95], v[84:87], v[64:79]
    ds_read_b64_tr_b16 v[168:169], v216 offset:53248
    ds_read_b64_tr_b16 v[170:171], v216 offset:54272
    v_mfma_f32_32x32x16_bf16 v[16:31], v[104:107], v[96:99], v[16:31]
    ds_read_b64_tr_b16 v[172:173], v217 offset:53248
    ds_read_b64_tr_b16 v[174:175], v217 offset:54272
    v_dot2c_f32_bf16 v220, s41, v90
    v_dot2c_f32_bf16 v218, s41, v83
    v_dot2c_f32_bf16 v219, v83, v83
    v_dot2c_f32_bf16 v220, s41, v91
    v_dot2c_f32_bf16 v218, s41, v96
    v_mfma_f32_32x32x16_bf16 v[32:47], v[104:107], v[100:103], v[32:47]
    ds_read_b128 v[160:163], v210 offset:32768
    ds_read_b128 v[164:167], v211 offset:32768
    ds_read_b64_tr_b16 v[184:185], v216 offset:57344
    v_dot2c_f32_bf16 v219, v96, v96
    v_dot2c_f32_bf16 v220, s41, v104
    v_dot2c_f32_bf16 v218, s41, v97
    v_dot2c_f32_bf16 v219, v97, v97
    v_mfma_f32_32x32x16_bf16 v[48:63], v[108:111], v[96:99], v[48:63]
    ds_read_b64_tr_b16 v[186:187], v216 offset:58368
    ds_read_b64_tr_b16 v[188:189], v217 offset:57344
    v_mfma_f32_32x32x16_bf16 v[64:79], v[108:111], v[100:103], v[64:79]
    ds_read_b64_tr_b16 v[190:191], v217 offset:58368
    ds_read_b128 v[176:179], v212 offset:32768
    v_dot2c_f32_bf16 v220, s41, v105
    v_dot2c_f32_bf16 v218, s41, v98
    v_dot2c_f32_bf16 v219, v98, v98
    v_dot2c_f32_bf16 v220, s41, v106
    v_mfma_f32_32x32x16_bf16 v[16:31], v[120:123], v[112:115], v[16:31]
    ds_read_b128 v[180:183], v213 offset:32768
    ds_read_b64_tr_b16 v[200:201], v216 offset:61440
    ds_read_b64_tr_b16 v[202:203], v216 offset:62464
    v_dot2c_f32_bf16 v218, s41, v99
    v_dot2c_f32_bf16 v219, v99, v99
    v_dot2c_f32_bf16 v220, s41, v107
    v_dot2c_f32_bf16 v218, s41, v112
    v_dot2c_f32_bf16 v219, v112, v112
    v_mfma_f32_32x32x16_bf16 v[32:47], v[120:123], v[116:119], v[32:47]
    ds_read_b64_tr_b16 v[204:205], v217 offset:61440
    ds_read_b64_tr_b16 v[206:207], v217 offset:62464
    v_mfma_f32_32x32x16_bf16 v[48:63], v[124:127], v[112:115], v[48:63]
    ds_read_b128 v[192:195], v214 offset:32768
    ds_read_b128 v[196:199], v215 offset:32768
    v_dot2c_f32_bf16 v220, s41, v120
    v_dot2c_f32_bf16 v218, s41, v113
    v_dot2c_f32_bf16 v219, v113, v113
    v_dot2c_f32_bf16 v220, s41, v121
    v_mfma_f32_32x32x16_bf16 v[64:79], v[124:127], v[116:119], v[64:79]
    v_dot2c_f32_bf16 v218, s41, v114
    v_dot2c_f32_bf16 v219, v114, v114
    v_dot2c_f32_bf16 v220, s41, v122
    v_dot2c_f32_bf16 v218, s41, v115
    v_mfma_f32_32x32x16_bf16 v[16:31], v[136:139], v[128:131], v[16:31]
    v_mfma_f32_32x32x16_bf16 v[32:47], v[136:139], v[132:135], v[32:47]
    v_dot2c_f32_bf16 v219, v115, v115
    v_dot2c_f32_bf16 v220, s41, v123
    v_dot2c_f32_bf16 v218, s41, v128
    v_dot2c_f32_bf16 v219, v128, v128
    v_dot2c_f32_bf16 v220, s41, v136
    v_mfma_f32_32x32x16_bf16 v[48:63], v[140:143], v[128:131], v[48:63]
    v_dot2c_f32_bf16 v218, s41, v129
    v_dot2c_f32_bf16 v219, v129, v129
    v_dot2c_f32_bf16 v220, s41, v137
    v_dot2c_f32_bf16 v218, s41, v130
    v_mfma_f32_32x32x16_bf16 v[64:79], v[140:143], v[132:135], v[64:79]
    s_waitcnt lgkmcnt(0)
    s_barrier
    v_dot2c_f32_bf16 v219, v130, v130
    v_dot2c_f32_bf16 v220, s41, v138
    v_dot2c_f32_bf16 v218, s41, v131
    v_dot2c_f32_bf16 v219, v131, v131
    v_dot2c_f32_bf16 v220, s41, v139
    v_mfma_f32_32x32x16_bf16 v[16:31], v[152:155], v[144:147], v[16:31]
    v_xor_b32 v208, 0x10000, v208
    v_xor_b32 v209, 0x10000, v209
    v_mfma_f32_32x32x16_bf16 v[32:47], v[152:155], v[148:151], v[32:47]
    v_xor_b32 v210, 0x10000, v210
    v_xor_b32 v211, 0x10000, v211
    v_dot2c_f32_bf16 v218, s41, v144
    v_dot2c_f32_bf16 v219, v144, v144
    v_dot2c_f32_bf16 v220, s41, v152
    v_dot2c_f32_bf16 v218, s41, v145
    v_mfma_f32_32x32x16_bf16 v[48:63], v[156:159], v[144:147], v[48:63]
    v_xor_b32 v212, 0x10000, v212
    v_xor_b32 v213, 0x10000, v213
    v_xor_b32 v214, 0x10000, v214
    v_xor_b32 v215, 0x10000, v215
    v_xor_b32 v216, 0x10000, v216
    v_dot2c_f32_bf16 v219, v145, v145
    v_dot2c_f32_bf16 v220, s41, v153
    v_dot2c_f32_bf16 v218, s41, v146
    v_dot2c_f32_bf16 v219, v146, v146
    v_mfma_f32_32x32x16_bf16 v[64:79], v[156:159], v[148:151], v[64:79]
    v_xor_b32 v217, 0x10000, v217
    ds_read_b64_tr_b16 v[88:89], v216 offset:16384
    v_mfma_f32_32x32x16_bf16 v[16:31], v[168:171], v[160:163], v[16:31]
    ds_read_b64_tr_b16 v[90:91], v216 offset:17408
    ds_read_b64_tr_b16 v[92:93], v217 offset:16384
    ds_read_b64_tr_b16 v[94:95], v217 offset:17408
    v_dot2c_f32_bf16 v220, s41, v154
    v_dot2c_f32_bf16 v218, s41, v147
    v_dot2c_f32_bf16 v219, v147, v147
    v_dot2c_f32_bf16 v220, s41, v155
    v_dot2c_f32_bf16 v218, s41, v160
    v_mfma_f32_32x32x16_bf16 v[32:47], v[168:171], v[164:167], v[32:47]
    ds_read_b128 v[80:83], v208 offset:0
    ds_read_b128 v[84:87], v209 offset:0
    ds_read_b64_tr_b16 v[104:105], v216 offset:20480
    ds_read_b64_tr_b16 v[106:107], v216 offset:21504
    ds_read_b64_tr_b16 v[108:109], v217 offset:20480
    v_dot2c_f32_bf16 v219, v160, v160
    v_dot2c_f32_bf16 v220, s41, v168
    v_dot2c_f32_bf16 v218, s41, v161
    v_dot2c_f32_bf16 v219, v161, v161
    v_mfma_f32_32x32x16_bf16 v[48:63], v[172:175], v[160:163], v[48:63]
    ds_read_b64_tr_b16 v[110:111], v217 offset:21504
    ds_read_b128 v[96:99], v210 offset:0
    v_mfma_f32_32x32x16_bf16 v[64:79], v[172:175], v[164:167], v[64:79]
    ds_read_b128 v[100:103], v211 offset:0
    ds_read_b64_tr_b16 v[120:121], v216 offset:24576
    ds_read_b64_tr_b16 v[122:123], v216 offset:25600
    v_dot2c_f32_bf16 v220, s41, v169
    v_dot2c_f32_bf16 v218, s41, v162
    v_dot2c_f32_bf16 v219, v162, v162
    v_dot2c_f32_bf16 v220, s41, v170
    v_dot2c_f32_bf16 v218, s41, v163
    v_mfma_f32_32x32x16_bf16 v[16:31], v[184:187], v[176:179], v[16:31]
    ds_read_b64_tr_b16 v[124:125], v217 offset:24576
    ds_read_b64_tr_b16 v[126:127], v217 offset:25600
    ds_read_b128 v[112:115], v212 offset:0
    ds_read_b128 v[116:119], v213 offset:0
    ds_read_b64_tr_b16 v[136:137], v216 offset:28672
    v_dot2c_f32_bf16 v219, v163, v163
    v_dot2c_f32_bf16 v220, s41, v171
    v_dot2c_f32_bf16 v218, s41, v176
    v_dot2c_f32_bf16 v219, v176, v176
    v_mfma_f32_32x32x16_bf16 v[32:47], v[184:187], v[180:183], v[32:47]
    ds_read_b64_tr_b16 v[138:139], v216 offset:29696
    ds_read_b64_tr_b16 v[140:141], v217 offset:28672
    v_mfma_f32_32x32x16_bf16 v[48:63], v[188:191], v[176:179], v[48:63]
    ds_read_b64_tr_b16 v[142:143], v217 offset:29696
    ds_read_b128 v[128:131], v214 offset:0
    ds_read_b128 v[132:135], v215 offset:0
    v_dot2c_f32_bf16 v220, s41, v184
    v_dot2c_f32_bf16 v218, s41, v177
    v_dot2c_f32_bf16 v219, v177, v177
    v_dot2c_f32_bf16 v220, s41, v185
    v_dot2c_f32_bf16 v218, s41, v178
    v_mfma_f32_32x32x16_bf16 v[64:79], v[188:191], v[180:183], v[64:79]
    v_dot2c_f32_bf16 v219, v178, v178
    v_dot2c_f32_bf16 v220, s41, v186
    v_dot2c_f32_bf16 v218, s41, v179
    v_dot2c_f32_bf16 v219, v179, v179
    v_mfma_f32_32x32x16_bf16 v[16:31], v[200:203], v[192:195], v[16:31]
    v_mfma_f32_32x32x16_bf16 v[32:47], v[200:203], v[196:199], v[32:47]
    v_dot2c_f32_bf16 v220, s41, v187
    v_dot2c_f32_bf16 v218, s41, v192
    v_dot2c_f32_bf16 v219, v192, v192
    v_dot2c_f32_bf16 v220, s41, v200
    v_dot2c_f32_bf16 v218, s41, v193
    v_mfma_f32_32x32x16_bf16 v[48:63], v[204:207], v[192:195], v[48:63]
    v_dot2c_f32_bf16 v219, v193, v193
    v_dot2c_f32_bf16 v220, s41, v201
    v_dot2c_f32_bf16 v218, s41, v194
    v_dot2c_f32_bf16 v219, v194, v194
    v_mfma_f32_32x32x16_bf16 v[64:79], v[204:207], v[196:199], v[64:79]
    s_waitcnt lgkmcnt(0)
    s_barrier
    v_dot2c_f32_bf16 v220, s41, v202
    v_dot2c_f32_bf16 v218, s41, v195
    v_dot2c_f32_bf16 v219, v195, v195
    v_dot2c_f32_bf16 v220, s41, v203
    buffer_load_dwordx2 v[254:255], v10, s[56:59], 0 offen sc1
    v_mfma_f32_32x32x16_bf16 v[16:31], v[88:91], v[80:83], v[16:31]
    ds_read_b64_tr_b16 v[152:153], v216 offset:49152
    v_mfma_f32_32x32x16_bf16 v[32:47], v[88:91], v[84:87], v[32:47]
    ds_read_b64_tr_b16 v[154:155], v216 offset:50176
    ds_read_b64_tr_b16 v[156:157], v217 offset:49152
    v_dot2c_f32_bf16 v218, s41, v80
    v_dot2c_f32_bf16 v219, v80, v80
    v_dot2c_f32_bf16 v220, s41, v88
    v_dot2c_f32_bf16 v218, s41, v81
    v_mfma_f32_32x32x16_bf16 v[48:63], v[92:95], v[80:83], v[48:63]
    ds_read_b64_tr_b16 v[158:159], v217 offset:50176
    ds_read_b128 v[144:147], v208 offset:32768
    ds_read_b128 v[148:151], v209 offset:32768
    v_dot2c_f32_bf16 v219, v81, v81
    v_dot2c_f32_bf16 v220, s41, v89
    v_dot2c_f32_bf16 v218, s41, v82
    v_dot2c_f32_bf16 v219, v82, v82
    v_mfma_f32_32x32x16_bf16 v[64:79], v[92:95], v[84:87], v[64:79]
    ds_read_b64_tr_b16 v[168:169], v216 offset:53248
    ds_read_b64_tr_b16 v[170:171], v216 offset:54272
    v_mfma_f32_32x32x16_bf16 v[16:31], v[104:107], v[96:99], v[16:31]
    ds_read_b64_tr_b16 v[172:173], v217 offset:53248
    ds_read_b64_tr_b16 v[174:175], v217 offset:54272
    v_dot2c_f32_bf16 v220, s41, v90
    v_dot2c_f32_bf16 v218, s41, v83
    v_dot2c_f32_bf16 v219, v83, v83
    v_dot2c_f32_bf16 v220, s41, v91
    v_dot2c_f32_bf16 v218, s41, v96
    v_mfma_f32_32x32x16_bf16 v[32:47], v[104:107], v[100:103], v[32:47]
    ds_read_b128 v[160:163], v210 offset:32768
    ds_read_b128 v[164:167], v211 offset:32768
    ds_read_b64_tr_b16 v[184:185], v216 offset:57344
    v_dot2c_f32_bf16 v219, v96, v96
    v_dot2c_f32_bf16 v220, s41, v104
    v_dot2c_f32_bf16 v218, s41, v97
    v_dot2c_f32_bf16 v219, v97, v97
    v_mfma_f32_32x32x16_bf16 v[48:63], v[108:111], v[96:99], v[48:63]
    ds_read_b64_tr_b16 v[186:187], v216 offset:58368
    ds_read_b64_tr_b16 v[188:189], v217 offset:57344
    v_mfma_f32_32x32x16_bf16 v[64:79], v[108:111], v[100:103], v[64:79]
    ds_read_b64_tr_b16 v[190:191], v217 offset:58368
    ds_read_b128 v[176:179], v212 offset:32768
    v_dot2c_f32_bf16 v220, s41, v105
    v_dot2c_f32_bf16 v218, s41, v98
    v_dot2c_f32_bf16 v219, v98, v98
    v_dot2c_f32_bf16 v220, s41, v106
    v_mfma_f32_32x32x16_bf16 v[16:31], v[120:123], v[112:115], v[16:31]
    ds_read_b128 v[180:183], v213 offset:32768
    ds_read_b64_tr_b16 v[200:201], v216 offset:61440
    ds_read_b64_tr_b16 v[202:203], v216 offset:62464
    v_dot2c_f32_bf16 v218, s41, v99
    v_dot2c_f32_bf16 v219, v99, v99
    v_dot2c_f32_bf16 v220, s41, v107
    v_dot2c_f32_bf16 v218, s41, v112
    v_dot2c_f32_bf16 v219, v112, v112
    v_mfma_f32_32x32x16_bf16 v[32:47], v[120:123], v[116:119], v[32:47]
    ds_read_b64_tr_b16 v[204:205], v217 offset:61440
    ds_read_b64_tr_b16 v[206:207], v217 offset:62464
    v_mfma_f32_32x32x16_bf16 v[48:63], v[124:127], v[112:115], v[48:63]
    ds_read_b128 v[192:195], v214 offset:32768
    ds_read_b128 v[196:199], v215 offset:32768
    v_dot2c_f32_bf16 v220, s41, v120
    v_dot2c_f32_bf16 v218, s41, v113
    v_dot2c_f32_bf16 v219, v113, v113
    v_dot2c_f32_bf16 v220, s41, v121
    v_mfma_f32_32x32x16_bf16 v[64:79], v[124:127], v[116:119], v[64:79]
    v_dot2c_f32_bf16 v218, s41, v114
    v_dot2c_f32_bf16 v219, v114, v114
    v_dot2c_f32_bf16 v220, s41, v122
    v_dot2c_f32_bf16 v218, s41, v115
    v_mfma_f32_32x32x16_bf16 v[16:31], v[136:139], v[128:131], v[16:31]
    v_mfma_f32_32x32x16_bf16 v[32:47], v[136:139], v[132:135], v[32:47]
    v_dot2c_f32_bf16 v219, v115, v115
    v_dot2c_f32_bf16 v220, s41, v123
    v_dot2c_f32_bf16 v218, s41, v128
    v_dot2c_f32_bf16 v219, v128, v128
    v_dot2c_f32_bf16 v220, s41, v136
    v_mfma_f32_32x32x16_bf16 v[48:63], v[140:143], v[128:131], v[48:63]
    v_dot2c_f32_bf16 v218, s41, v129
    v_dot2c_f32_bf16 v219, v129, v129
    v_dot2c_f32_bf16 v220, s41, v137
    v_dot2c_f32_bf16 v218, s41, v130
    v_mfma_f32_32x32x16_bf16 v[64:79], v[140:143], v[132:135], v[64:79]
    s_waitcnt lgkmcnt(0)
    s_barrier
    v_dot2c_f32_bf16 v219, v130, v130
    v_dot2c_f32_bf16 v220, s41, v138
    v_dot2c_f32_bf16 v218, s41, v131
    v_dot2c_f32_bf16 v219, v131, v131
    v_dot2c_f32_bf16 v220, s41, v139
    v_mfma_f32_32x32x16_bf16 v[16:31], v[152:155], v[144:147], v[16:31]
    v_xor_b32 v208, 0x10000, v208
    v_xor_b32 v209, 0x10000, v209
    v_mfma_f32_32x32x16_bf16 v[32:47], v[152:155], v[148:151], v[32:47]
    v_xor_b32 v210, 0x10000, v210
    v_xor_b32 v211, 0x10000, v211
    v_dot2c_f32_bf16 v218, s41, v144
    v_dot2c_f32_bf16 v219, v144, v144
    v_dot2c_f32_bf16 v220, s41, v152
    v_dot2c_f32_bf16 v218, s41, v145
    v_mfma_f32_32x32x16_bf16 v[48:63], v[156:159], v[144:147], v[48:63]
    v_xor_b32 v212, 0x10000, v212
    v_xor_b32 v213, 0x10000, v213
    v_xor_b32 v214, 0x10000, v214
    v_xor_b32 v215, 0x10000, v215
    v_xor_b32 v216, 0x10000, v216
    v_dot2c_f32_bf16 v219, v145, v145
    v_dot2c_f32_bf16 v220, s41, v153
    v_dot2c_f32_bf16 v218, s41, v146
    v_dot2c_f32_bf16 v219, v146, v146
    v_mfma_f32_32x32x16_bf16 v[64:79], v[156:159], v[148:151], v[64:79]
    v_xor_b32 v217, 0x10000, v217
    ds_read_b64_tr_b16 v[88:89], v216 offset:16384
    v_mfma_f32_32x32x16_bf16 v[16:31], v[168:171], v[160:163], v[16:31]
    ds_read_b64_tr_b16 v[90:91], v216 offset:17408
    ds_read_b64_tr_b16 v[92:93], v217 offset:16384
    ds_read_b64_tr_b16 v[94:95], v217 offset:17408
    v_dot2c_f32_bf16 v220, s41, v154
    v_dot2c_f32_bf16 v218, s41, v147
    v_dot2c_f32_bf16 v219, v147, v147
    v_dot2c_f32_bf16 v220, s41, v155
    v_dot2c_f32_bf16 v218, s41, v160
    v_mfma_f32_32x32x16_bf16 v[32:47], v[168:171], v[164:167], v[32:47]
    ds_read_b128 v[80:83], v208 offset:0
    ds_read_b128 v[84:87], v209 offset:0
    ds_read_b64_tr_b16 v[104:105], v216 offset:20480
    ds_read_b64_tr_b16 v[106:107], v216 offset:21504
    ds_read_b64_tr_b16 v[108:109], v217 offset:20480
    v_dot2c_f32_bf16 v219, v160, v160
    v_dot2c_f32_bf16 v220, s41, v168
    v_dot2c_f32_bf16 v218, s41, v161
    v_dot2c_f32_bf16 v219, v161, v161
    v_mfma_f32_32x32x16_bf16 v[48:63], v[172:175], v[160:163], v[48:63]
    ds_read_b64_tr_b16 v[110:111], v217 offset:21504
    ds_read_b128 v[96:99], v210 offset:0
    v_mfma_f32_32x32x16_bf16 v[64:79], v[172:175], v[164:167], v[64:79]
    ds_read_b128 v[100:103], v211 offset:0
    ds_read_b64_tr_b16 v[120:121], v216 offset:24576
    ds_read_b64_tr_b16 v[122:123], v216 offset:25600
    v_dot2c_f32_bf16 v220, s41, v169
    v_dot2c_f32_bf16 v218, s41, v162
    v_dot2c_f32_bf16 v219, v162, v162
    v_dot2c_f32_bf16 v220, s41, v170
    v_mfma_f32_32x32x16_bf16 v[16:31], v[184:187], v[176:179], v[16:31]
    ds_read_b64_tr_b16 v[124:125], v217 offset:24576
    ds_read_b64_tr_b16 v[126:127], v217 offset:25600
    ds_read_b128 v[112:115], v212 offset:0
    ds_read_b128 v[116:119], v213 offset:0
    ds_read_b64_tr_b16 v[136:137], v216 offset:28672
    v_dot2c_f32_bf16 v218, s41, v163
    v_dot2c_f32_bf16 v219, v163, v163
    v_dot2c_f32_bf16 v220, s41, v171
    v_dot2c_f32_bf16 v218, s41, v176
    v_dot2c_f32_bf16 v219, v176, v176
    v_mfma_f32_32x32x16_bf16 v[32:47], v[184:187], v[180:183], v[32:47]
    ds_read_b64_tr_b16 v[138:139], v216 offset:29696
    ds_read_b64_tr_b16 v[140:141], v217 offset:28672
    v_mfma_f32_32x32x16_bf16 v[48:63], v[188:191], v[176:179], v[48:63]
    ds_read_b64_tr_b16 v[142:143], v217 offset:29696
    ds_read_b128 v[128:131], v214 offset:0
    ds_read_b128 v[132:135], v215 offset:0
    v_dot2c_f32_bf16 v220, s41, v184
    v_dot2c_f32_bf16 v218, s41, v177
    v_dot2c_f32_bf16 v219, v177, v177
    v_dot2c_f32_bf16 v220, s41, v185
    v_mfma_f32_32x32x16_bf16 v[64:79], v[188:191], v[180:183], v[64:79]
    v_dot2c_f32_bf16 v218, s41, v178
    v_dot2c_f32_bf16 v219, v178, v178
    v_dot2c_f32_bf16 v220, s41, v186
    v_dot2c_f32_bf16 v218, s41, v179
    v_mfma_f32_32x32x16_bf16 v[16:31], v[200:203], v[192:195], v[16:31]
    v_mfma_f32_32x32x16_bf16 v[32:47], v[200:203], v[196:199], v[32:47]
    v_dot2c_f32_bf16 v219, v179, v179
    v_dot2c_f32_bf16 v220, s41, v187
    v_dot2c_f32_bf16 v218, s41, v192
    v_dot2c_f32_bf16 v219, v192, v192
    v_dot2c_f32_bf16 v220, s41, v200
    v_mfma_f32_32x32x16_bf16 v[48:63], v[204:207], v[192:195], v[48:63]
    v_dot2c_f32_bf16 v218, s41, v193
    v_dot2c_f32_bf16 v219, v193, v193
    v_dot2c_f32_bf16 v220, s41, v201
    v_dot2c_f32_bf16 v218, s41, v194
    v_mfma_f32_32x32x16_bf16 v[64:79], v[204:207], v[196:199], v[64:79]
    s_waitcnt lgkmcnt(0)
    s_barrier
    v_dot2c_f32_bf16 v219, v194, v194
    v_dot2c_f32_bf16 v220, s41, v202
    v_dot2c_f32_bf16 v218, s41, v195
    v_dot2c_f32_bf16 v219, v195, v195
    v_dot2c_f32_bf16 v220, s41, v203
    v_mfma_f32_32x32x16_bf16 v[16:31], v[88:91], v[80:83], v[16:31]
    ds_read_b64_tr_b16 v[152:153], v216 offset:49152
    v_mfma_f32_32x32x16_bf16 v[32:47], v[88:91], v[84:87], v[32:47]
    ds_read_b64_tr_b16 v[154:155], v216 offset:50176
    ds_read_b64_tr_b16 v[156:157], v217 offset:49152
    v_dot2c_f32_bf16 v218, s41, v80
    v_dot2c_f32_bf16 v219, v80, v80
    v_dot2c_f32_bf16 v220, s41, v88
    v_dot2c_f32_bf16 v218, s41, v81
    v_mfma_f32_32x32x16_bf16 v[48:63], v[92:95], v[80:83], v[48:63]
    ds_read_b64_tr_b16 v[158:159], v217 offset:50176
    ds_read_b128 v[144:147], v208 offset:32768
    ds_read_b128 v[148:151], v209 offset:32768
    v_dot2c_f32_bf16 v219, v81, v81
    v_dot2c_f32_bf16 v220, s41, v89
    v_dot2c_f32_bf16 v218, s41, v82
    v_dot2c_f32_bf16 v219, v82, v82
    v_mfma_f32_32x32x16_bf16 v[64:79], v[92:95], v[84:87], v[64:79]
    ds_read_b64_tr_b16 v[168:169], v216 offset:53248
    ds_read_b64_tr_b16 v[170:171], v216 offset:54272
    v_mfma_f32_32x32x16_bf16 v[16:31], v[104:107], v[96:99], v[16:31]
    ds_read_b64_tr_b16 v[172:173], v217 offset:53248
    ds_read_b64_tr_b16 v[174:175], v217 offset:54272
    v_dot2c_f32_bf16 v220, s41, v90
    v_dot2c_f32_bf16 v218, s41, v83
    v_dot2c_f32_bf16 v219, v83, v83
    v_dot2c_f32_bf16 v220, s41, v91
    v_dot2c_f32_bf16 v218, s41, v96
    v_mfma_f32_32x32x16_bf16 v[32:47], v[104:107], v[100:103], v[32:47]
    ds_read_b128 v[160:163], v210 offset:32768
    ds_read_b128 v[164:167], v211 offset:32768
    ds_read_b64_tr_b16 v[184:185], v216 offset:57344
    v_dot2c_f32_bf16 v219, v96, v96
    v_dot2c_f32_bf16 v220, s41, v104
    v_dot2c_f32_bf16 v218, s41, v97
    v_dot2c_f32_bf16 v219, v97, v97
    v_mfma_f32_32x32x16_bf16 v[48:63], v[108:111], v[96:99], v[48:63]
    ds_read_b64_tr_b16 v[186:187], v216 offset:58368
    ds_read_b64_tr_b16 v[188:189], v217 offset:57344
    v_mfma_f32_32x32x16_bf16 v[64:79], v[108:111], v[100:103], v[64:79]
    ds_read_b64_tr_b16 v[190:191], v217 offset:58368
    ds_read_b128 v[176:179], v212 offset:32768
    v_dot2c_f32_bf16 v220, s41, v105
    v_dot2c_f32_bf16 v218, s41, v98
    v_dot2c_f32_bf16 v219, v98, v98
    v_dot2c_f32_bf16 v220, s41, v106
    v_mfma_f32_32x32x16_bf16 v[16:31], v[120:123], v[112:115], v[16:31]
    ds_read_b128 v[180:183], v213 offset:32768
    ds_read_b64_tr_b16 v[200:201], v216 offset:61440
    ds_read_b64_tr_b16 v[202:203], v216 offset:62464
    v_dot2c_f32_bf16 v218, s41, v99
    v_dot2c_f32_bf16 v219, v99, v99
    v_dot2c_f32_bf16 v220, s41, v107
    v_dot2c_f32_bf16 v218, s41, v112
    v_dot2c_f32_bf16 v219, v112, v112
    v_mfma_f32_32x32x16_bf16 v[32:47], v[120:123], v[116:119], v[32:47]
    ds_read_b64_tr_b16 v[204:205], v217 offset:61440
    ds_read_b64_tr_b16 v[206:207], v217 offset:62464
    v_mfma_f32_32x32x16_bf16 v[48:63], v[124:127], v[112:115], v[48:63]
    ds_read_b128 v[192:195], v214 offset:32768
    ds_read_b128 v[196:199], v215 offset:32768
    v_dot2c_f32_bf16 v220, s41, v120
    v_dot2c_f32_bf16 v218, s41, v113
    v_dot2c_f32_bf16 v219, v113, v113
    v_dot2c_f32_bf16 v220, s41, v121
    v_mfma_f32_32x32x16_bf16 v[64:79], v[124:127], v[116:119], v[64:79]
    v_dot2c_f32_bf16 v218, s41, v114
    v_dot2c_f32_bf16 v219, v114, v114
    v_dot2c_f32_bf16 v220, s41, v122
    v_dot2c_f32_bf16 v218, s41, v115
    v_mfma_f32_32x32x16_bf16 v[16:31], v[136:139], v[128:131], v[16:31]
    v_mfma_f32_32x32x16_bf16 v[32:47], v[136:139], v[132:135], v[32:47]
    v_dot2c_f32_bf16 v219, v115, v115
    v_dot2c_f32_bf16 v220, s41, v123
    v_dot2c_f32_bf16 v218, s41, v128
    v_dot2c_f32_bf16 v219, v128, v128
    v_dot2c_f32_bf16 v220, s41, v136
    v_mfma_f32_32x32x16_bf16 v[48:63], v[140:143], v[128:131], v[48:63]
    v_dot2c_f32_bf16 v218, s41, v129
    v_dot2c_f32_bf16 v219, v129, v129
    v_dot2c_f32_bf16 v220, s41, v137
    v_dot2c_f32_bf16 v218, s41, v130
    v_mfma_f32_32x32x16_bf16 v[64:79], v[140:143], v[132:135], v[64:79]
    s_waitcnt lgkmcnt(0)
    s_barrier
    v_dot2c_f32_bf16 v219, v130, v130
    v_dot2c_f32_bf16 v220, s41, v138
    v_dot2c_f32_bf16 v218, s41, v131
    v_dot2c_f32_bf16 v219, v131, v131
    v_dot2c_f32_bf16 v220, s41, v139
    v_mfma_f32_32x32x16_bf16 v[16:31], v[152:155], v[144:147], v[16:31]
    v_xor_b32 v208, 0x10000, v208
    v_xor_b32 v209, 0x10000, v209
    v_mfma_f32_32x32x16_bf16 v[32:47], v[152:155], v[148:151], v[32:47]
    v_xor_b32 v210, 0x10000, v210
    v_xor_b32 v211, 0x10000, v211
    v_dot2c_f32_bf16 v218, s41, v144
    v_dot2c_f32_bf16 v219, v144, v144
    v_dot2c_f32_bf16 v220, s41, v152
    v_dot2c_f32_bf16 v218, s41, v145
    v_mfma_f32_32x32x16_bf16 v[48:63], v[156:159], v[144:147], v[48:63]
    v_xor_b32 v212, 0x10000, v212
    v_xor_b32 v213, 0x10000, v213
    v_xor_b32 v214, 0x10000, v214
    v_xor_b32 v215, 0x10000, v215
    v_xor_b32 v216, 0x10000, v216
    v_dot2c_f32_bf16 v219, v145, v145
    v_dot2c_f32_bf16 v220, s41, v153
    v_dot2c_f32_bf16 v218, s41, v146
    v_dot2c_f32_bf16 v219, v146, v146
    v_mfma_f32_32x32x16_bf16 v[64:79], v[156:159], v[148:151], v[64:79]
    v_xor_b32 v217, 0x10000, v217
    ds_read_b64_tr_b16 v[88:89], v216 offset:16384
    v_mfma_f32_32x32x16_bf16 v[16:31], v[168:171], v[160:163], v[16:31]
    ds_read_b64_tr_b16 v[90:91], v216 offset:17408
    ds_read_b64_tr_b16 v[92:93], v217 offset:16384
    ds_read_b64_tr_b16 v[94:95], v217 offset:17408
    v_dot2c_f32_bf16 v220, s41, v154
    v_dot2c_f32_bf16 v218, s41, v147
    v_dot2c_f32_bf16 v219, v147, v147
    v_dot2c_f32_bf16 v220, s41, v155
    v_dot2c_f32_bf16 v218, s41, v160
    v_mfma_f32_32x32x16_bf16 v[32:47], v[168:171], v[164:167], v[32:47]
    ds_read_b128 v[80:83], v208 offset:0
    ds_read_b128 v[84:87], v209 offset:0
    ds_read_b64_tr_b16 v[104:105], v216 offset:20480
    ds_read_b64_tr_b16 v[106:107], v216 offset:21504
    ds_read_b64_tr_b16 v[108:109], v217 offset:20480
    v_dot2c_f32_bf16 v219, v160, v160
    v_dot2c_f32_bf16 v220, s41, v168
    v_dot2c_f32_bf16 v218, s41, v161
    v_dot2c_f32_bf16 v219, v161, v161
    v_mfma_f32_32x32x16_bf16 v[48:63], v[172:175], v[160:163], v[48:63]
    ds_read_b64_tr_b16 v[110:111], v217 offset:21504
    ds_read_b128 v[96:99], v210 offset:0
    v_mfma_f32_32x32x16_bf16 v[64:79], v[172:175], v[164:167], v[64:79]
    ds_read_b128 v[100:103], v211 offset:0
    ds_read_b64_tr_b16 v[120:121], v216 offset:24576
    ds_read_b64_tr_b16 v[122:123], v216 offset:25600
    v_dot2c_f32_bf16 v220, s41, v169
    v_dot2c_f32_bf16 v218, s41, v162
    v_dot2c_f32_bf16 v219, v162, v162
    v_dot2c_f32_bf16 v220, s41, v170
    v_mfma_f32_32x32x16_bf16 v[16:31], v[184:187], v[176:179], v[16:31]
    ds_read_b64_tr_b16 v[124:125], v217 offset:24576
    ds_read_b64_tr_b16 v[126:127], v217 offset:25600
    ds_read_b128 v[112:115], v212 offset:0
    ds_read_b128 v[116:119], v213 offset:0
    ds_read_b64_tr_b16 v[136:137], v216 offset:28672
    v_dot2c_f32_bf16 v218, s41, v163
    v_dot2c_f32_bf16 v219, v163, v163
    v_dot2c_f32_bf16 v220, s41, v171
    v_dot2c_f32_bf16 v218, s41, v176
    v_dot2c_f32_bf16 v219, v176, v176
    v_mfma_f32_32x32x16_bf16 v[32:47], v[184:187], v[180:183], v[32:47]
    ds_read_b64_tr_b16 v[138:139], v216 offset:29696
    ds_read_b64_tr_b16 v[140:141], v217 offset:28672
    v_mfma_f32_32x32x16_bf16 v[48:63], v[188:191], v[176:179], v[48:63]
    ds_read_b64_tr_b16 v[142:143], v217 offset:29696
    ds_read_b128 v[128:131], v214 offset:0
    ds_read_b128 v[132:135], v215 offset:0
    v_dot2c_f32_bf16 v220, s41, v184
    v_dot2c_f32_bf16 v218, s41, v177
    v_dot2c_f32_bf16 v219, v177, v177
    v_dot2c_f32_bf16 v220, s41, v185
    v_mfma_f32_32x32x16_bf16 v[64:79], v[188:191], v[180:183], v[64:79]
    v_dot2c_f32_bf16 v218, s41, v178
    v_dot2c_f32_bf16 v219, v178, v178
    v_dot2c_f32_bf16 v220, s41, v186
    v_dot2c_f32_bf16 v218, s41, v179
    v_mfma_f32_32x32x16_bf16 v[16:31], v[200:203], v[192:195], v[16:31]
    v_mfma_f32_32x32x16_bf16 v[32:47], v[200:203], v[196:199], v[32:47]
    v_dot2c_f32_bf16 v219, v179, v179
    v_dot2c_f32_bf16 v220, s41, v187
    v_dot2c_f32_bf16 v218, s41, v192
    v_dot2c_f32_bf16 v219, v192, v192
    v_dot2c_f32_bf16 v220, s41, v200
    v_mfma_f32_32x32x16_bf16 v[48:63], v[204:207], v[192:195], v[48:63]
    v_dot2c_f32_bf16 v218, s41, v193
    v_dot2c_f32_bf16 v219, v193, v193
    v_dot2c_f32_bf16 v220, s41, v201
    v_dot2c_f32_bf16 v218, s41, v194
    v_mfma_f32_32x32x16_bf16 v[64:79], v[204:207], v[196:199], v[64:79]
    s_waitcnt lgkmcnt(0)
    s_barrier
    v_dot2c_f32_bf16 v219, v194, v194
    v_dot2c_f32_bf16 v220, s41, v202
    v_dot2c_f32_bf16 v218, s41, v195
    v_dot2c_f32_bf16 v219, v195, v195
    v_dot2c_f32_bf16 v220, s41, v203
    v_mfma_f32_32x32x16_bf16 v[16:31], v[88:91], v[80:83], v[16:31]
    ds_read_b64_tr_b16 v[152:153], v216 offset:49152
    v_mfma_f32_32x32x16_bf16 v[32:47], v[88:91], v[84:87], v[32:47]
    ds_read_b64_tr_b16 v[154:155], v216 offset:50176
    ds_read_b64_tr_b16 v[156:157], v217 offset:49152
    v_dot2c_f32_bf16 v218, s41, v80
    v_dot2c_f32_bf16 v219, v80, v80
    v_dot2c_f32_bf16 v220, s41, v88
    v_dot2c_f32_bf16 v218, s41, v81
    v_mfma_f32_32x32x16_bf16 v[48:63], v[92:95], v[80:83], v[48:63]
    ds_read_b64_tr_b16 v[158:159], v217 offset:50176
    ds_read_b128 v[144:147], v208 offset:32768
    ds_read_b128 v[148:151], v209 offset:32768
    v_dot2c_f32_bf16 v219, v81, v81
    v_dot2c_f32_bf16 v220, s41, v89
    v_dot2c_f32_bf16 v218, s41, v82
    v_dot2c_f32_bf16 v219, v82, v82
    v_mfma_f32_32x32x16_bf16 v[64:79], v[92:95], v[84:87], v[64:79]
    ds_read_b64_tr_b16 v[168:169], v216 offset:53248
    ds_read_b64_tr_b16 v[170:171], v216 offset:54272
    v_mfma_f32_32x32x16_bf16 v[16:31], v[104:107], v[96:99], v[16:31]
    ds_read_b64_tr_b16 v[172:173], v217 offset:53248
    ds_read_b64_tr_b16 v[174:175], v217 offset:54272
    v_dot2c_f32_bf16 v220, s41, v90
    v_dot2c_f32_bf16 v218, s41, v83
    v_dot2c_f32_bf16 v219, v83, v83
    v_dot2c_f32_bf16 v220, s41, v91
    v_dot2c_f32_bf16 v218, s41, v96
    v_mfma_f32_32x32x16_bf16 v[32:47], v[104:107], v[100:103], v[32:47]
    ds_read_b128 v[160:163], v210 offset:32768
    ds_read_b128 v[164:167], v211 offset:32768
    ds_read_b64_tr_b16 v[184:185], v216 offset:57344
    v_dot2c_f32_bf16 v219, v96, v96
    v_dot2c_f32_bf16 v220, s41, v104
    v_dot2c_f32_bf16 v218, s41, v97
    v_dot2c_f32_bf16 v219, v97, v97
    v_mfma_f32_32x32x16_bf16 v[48:63], v[108:111], v[96:99], v[48:63]
    ds_read_b64_tr_b16 v[186:187], v216 offset:58368
    ds_read_b64_tr_b16 v[188:189], v217 offset:57344
    v_mfma_f32_32x32x16_bf16 v[64:79], v[108:111], v[100:103], v[64:79]
    ds_read_b64_tr_b16 v[190:191], v217 offset:58368
    ds_read_b128 v[176:179], v212 offset:32768
    v_dot2c_f32_bf16 v220, s41, v105
    v_dot2c_f32_bf16 v218, s41, v98
    v_dot2c_f32_bf16 v219, v98, v98
    v_dot2c_f32_bf16 v220, s41, v106
    v_mfma_f32_32x32x16_bf16 v[16:31], v[120:123], v[112:115], v[16:31]
    ds_read_b128 v[180:183], v213 offset:32768
    ds_read_b64_tr_b16 v[200:201], v216 offset:61440
    ds_read_b64_tr_b16 v[202:203], v216 offset:62464
    v_dot2c_f32_bf16 v218, s41, v99
    v_dot2c_f32_bf16 v219, v99, v99
    v_dot2c_f32_bf16 v220, s41, v107
    v_dot2c_f32_bf16 v218, s41, v112
    v_dot2c_f32_bf16 v219, v112, v112
    v_mfma_f32_32x32x16_bf16 v[32:47], v[120:123], v[116:119], v[32:47]
    ds_read_b64_tr_b16 v[204:205], v217 offset:61440
    ds_read_b64_tr_b16 v[206:207], v217 offset:62464
    v_mfma_f32_32x32x16_bf16 v[48:63], v[124:127], v[112:115], v[48:63]
    ds_read_b128 v[192:195], v214 offset:32768
    ds_read_b128 v[196:199], v215 offset:32768
    v_dot2c_f32_bf16 v220, s41, v120
    v_dot2c_f32_bf16 v218, s41, v113
    v_dot2c_f32_bf16 v219, v113, v113
    v_dot2c_f32_bf16 v220, s41, v121
    v_mfma_f32_32x32x16_bf16 v[64:79], v[124:127], v[116:119], v[64:79]
    v_dot2c_f32_bf16 v218, s41, v114
    v_dot2c_f32_bf16 v219, v114, v114
    v_dot2c_f32_bf16 v220, s41, v122
    v_dot2c_f32_bf16 v218, s41, v115
    v_mfma_f32_32x32x16_bf16 v[16:31], v[136:139], v[128:131], v[16:31]
    v_mfma_f32_32x32x16_bf16 v[32:47], v[136:139], v[132:135], v[32:47]
    v_dot2c_f32_bf16 v219, v115, v115
    v_dot2c_f32_bf16 v220, s41, v123
    v_dot2c_f32_bf16 v218, s41, v128
    v_dot2c_f32_bf16 v219, v128, v128
    v_dot2c_f32_bf16 v220, s41, v136
    v_mfma_f32_32x32x16_bf16 v[48:63], v[140:143], v[128:131], v[48:63]
    v_dot2c_f32_bf16 v218, s41, v129
    v_dot2c_f32_bf16 v219, v129, v129
    v_dot2c_f32_bf16 v220, s41, v137
    v_dot2c_f32_bf16 v218, s41, v130
    v_mfma_f32_32x32x16_bf16 v[64:79], v[140:143], v[132:135], v[64:79]
    s_waitcnt lgkmcnt(0)
    v_dot2c_f32_bf16 v219, v130, v130
    v_dot2c_f32_bf16 v220, s41, v138
    v_dot2c_f32_bf16 v218, s41, v131
    v_dot2c_f32_bf16 v219, v131, v131
    v_dot2c_f32_bf16 v220, s41, v139
    v_dot2c_f32_bf16 v218, s41, v144
    v_dot2c_f32_bf16 v219, v144, v144
    v_dot2c_f32_bf16 v220, s41, v152
    v_dot2c_f32_bf16 v218, s41, v145
    v_dot2c_f32_bf16 v219, v145, v145
    v_dot2c_f32_bf16 v220, s41, v153
    v_dot2c_f32_bf16 v218, s41, v146
    v_dot2c_f32_bf16 v219, v146, v146
    v_dot2c_f32_bf16 v220, s41, v154
    v_dot2c_f32_bf16 v218, s41, v147
    v_dot2c_f32_bf16 v219, v147, v147
    v_dot2c_f32_bf16 v220, s41, v155
    v_dot2c_f32_bf16 v218, s41, v160
    v_dot2c_f32_bf16 v219, v160, v160
    v_dot2c_f32_bf16 v220, s41, v168
    v_dot2c_f32_bf16 v218, s41, v161
    v_dot2c_f32_bf16 v219, v161, v161
    v_dot2c_f32_bf16 v220, s41, v169
    v_dot2c_f32_bf16 v218, s41, v162
    v_dot2c_f32_bf16 v219, v162, v162
    v_dot2c_f32_bf16 v220, s41, v170
    v_dot2c_f32_bf16 v218, s41, v163
    v_dot2c_f32_bf16 v219, v163, v163
    v_dot2c_f32_bf16 v220, s41, v171
    v_dot2c_f32_bf16 v218, s41, v176
    v_dot2c_f32_bf16 v219, v176, v176
    v_dot2c_f32_bf16 v220, s41, v184
    v_dot2c_f32_bf16 v218, s41, v177
    v_dot2c_f32_bf16 v219, v177, v177
    v_dot2c_f32_bf16 v220, s41, v185
    v_dot2c_f32_bf16 v218, s41, v178
    v_dot2c_f32_bf16 v219, v178, v178
    v_dot2c_f32_bf16 v220, s41, v186
    v_dot2c_f32_bf16 v218, s41, v179
    v_dot2c_f32_bf16 v219, v179, v179
    v_dot2c_f32_bf16 v220, s41, v187
    v_dot2c_f32_bf16 v218, s41, v192
    v_dot2c_f32_bf16 v219, v192, v192
    v_dot2c_f32_bf16 v220, s41, v200
    v_dot2c_f32_bf16 v218, s41, v193
    v_dot2c_f32_bf16 v219, v193, v193
    v_dot2c_f32_bf16 v220, s41, v201
    v_dot2c_f32_bf16 v218, s41, v194
    v_dot2c_f32_bf16 v219, v194, v194
    v_dot2c_f32_bf16 v220, s41, v202
    v_dot2c_f32_bf16 v218, s41, v195
    v_dot2c_f32_bf16 v219, v195, v195
    v_dot2c_f32_bf16 v220, s41, v203
    v_mfma_f32_32x32x16_bf16 v[16:31], v[152:155], v[144:147], v[16:31]
    v_mov_b32 v3, v218
    s_nop 1
    v_permlane32_swap_b32 v218, v3
    v_add_f32 v218, v218, v3
    v_mfma_f32_32x32x16_bf16 v[32:47], v[152:155], v[148:151], v[32:47]
    v_mov_b32 v3, v219
    s_nop 1
    v_permlane32_swap_b32 v219, v3
    v_add_f32 v219, v219, v3
    v_mov_b32 v3, v220
    v_mfma_f32_32x32x16_bf16 v[48:63], v[156:159], v[144:147], v[48:63]
    s_nop 1
    v_permlane32_swap_b32 v220, v3
    v_add_f32 v220, v220, v3
    v_mul_f32 v5, 0x3acccccd, v218
    v_mfma_f32_32x32x16_bf16 v[64:79], v[156:159], v[148:151], v[64:79]
    v_mul_f32 v3, 0x3acccccd, v219
    v_fma_f32 v3, -v5, v5, v3
    v_max_f32 v3, 0, v3
    v_cvt_pk_bf16_f32 v3, v3, v3
    v_lshlrev_b32 v3, 16, v3
    v_mfma_f32_32x32x16_bf16 v[16:31], v[168:171], v[160:163], v[16:31]
    v_add_f32 v3, 0x3727c5ac, v3
    v_cvt_pk_bf16_f32 v3, v3, v3
    v_lshlrev_b32 v3, 16, v3
    v_sqrt_f32 v6, v3
    v_mfma_f32_32x32x16_bf16 v[32:47], v[168:171], v[164:167], v[32:47]
    v_cvt_pk_bf16_f32 v224, -v5, -v5
    v_cvt_pk_bf16_f32 v225, -v5, v6
    v_cvt_pk_bf16_f32 v3, v220, v220
    v_lshlrev_b32 v3, 16, v3
    v_sub_f32 v3, v220, v3
    v_mfma_f32_32x32x16_bf16 v[48:63], v[172:175], v[160:163], v[48:63]
    v_cvt_pk_bf16_f32 v228, v220, v3
    v_and_b32 v4, 0xffff0000, v228
    v_sub_f32 v3, v3, v4
    s_waitcnt vmcnt(0)
    v_mfma_f32_32x32x16_bf16 v[64:79], v[172:175], v[164:167], v[64:79]
    v_cvt_pk_bf16_f32 v229, v3, v221
    ds_write_b64 v7, v[224:225]
    ds_write_b64 v8, v[228:229] offset:1024
    v_xor_b32 v7, 0x100, v7
    v_xor_b32 v8, 0x100, v8
    v_mfma_f32_32x32x16_bf16 v[16:31], v[184:187], v[176:179], v[16:31]
    v_mfma_f32_32x32x16_bf16 v[32:47], v[184:187], v[180:183], v[32:47]
    s_waitcnt lgkmcnt(0)
    s_barrier
    ds_read_b64 v[232:233], v7
    ds_read_b64 v[236:237], v8 offset:1024
    v_mfma_f32_32x32x16_bf16 v[48:63], v[188:191], v[176:179], v[48:63]
    v_mfma_f32_32x32x16_bf16 v[64:79], v[188:191], v[180:183], v[64:79]
    v_mfma_f32_32x32x16_bf16 v[16:31], v[200:203], v[192:195], v[16:31]
    v_mfma_f32_32x32x16_bf16 v[32:47], v[200:203], v[196:199], v[32:47]
    v_cmp_eq_u32 vcc, 0, v2
    s_waitcnt lgkmcnt(0)
    v_mfma_f32_32x32x16_bf16 v[48:63], v[204:207], v[192:195], v[48:63]
    v_cndmask_b32 v228, 0, v228, vcc
    v_cndmask_b32 v229, 0, v229, vcc
    v_cndmask_b32 v236, 0, v236, vcc
    v_cndmask_b32 v237, 0, v237, vcc
    v_mfma_f32_32x32x16_bf16 v[64:79], v[204:207], v[196:199], v[64:79]
    v_and_b32 v242, 0xffff0000, v225
    v_rcp_f32 v3, v242
    s_nop 0
    v_mul_f32 v240, 0xc0135761, v3
    v_mul_f32 v4, v3, v3
    v_mfma_f32_32x32x16_bf16 v[16:31], v[228:231], v[224:227], v[16:31]
    v_mul_f32 v4, v4, v3
    v_mul_f32 v241, 0xbdd2d3e8, v4
    v_mfma_f32_32x32x16_bf16 v[32:47], v[228:231], v[232:235], v[32:47]
    v_and_b32 v246, 0xffff0000, v233
    v_rcp_f32 v3, v246
    v_mfma_f32_32x32x16_bf16 v[48:63], v[236:239], v[224:227], v[48:63]
    v_mul_f32 v244, 0xc0135761, v3
    v_mul_f32 v4, v3, v3
    v_mfma_f32_32x32x16_bf16 v[64:79], v[236:239], v[232:235], v[64:79]
    v_mul_f32 v4, v4, v3
    v_mul_f32 v245, 0xbdd2d3e8, v4
    s_waitcnt vmcnt(0)
    s_mov_b32 s3, 0
Lcc4:
    v_readfirstlane_b32 s49, v254
    s_add_u32 s3, s3, 1
    s_cmp_lg_u32 s49, 0
    s_cbranch_scc1 Lcd4
    s_cmp_ge_u32 s3, 131072
    s_cbranch_scc1 Lcd4
    buffer_load_dwordx2 v[254:255], v10, s[56:59], 0 offen sc1
    s_waitcnt vmcnt(0)
    s_branch Lcc4
Lcd4:
    v_readfirstlane_b32 s98, v254
    v_readfirstlane_b32 s99, v255
    s_mov_b32 s51, 0
    s_cmp_ge_u32 s35, 27
    s_cbranch_scc1 Lp2
    v_pk_mul_f32 v[80:81], v[16:17], v[16:17]
    v_pk_mul_f32 v[82:83], v[18:19], v[18:19]
    v_pk_mul_f32 v[84:85], v[20:21], v[20:21]
    v_pk_mul_f32 v[86:87], v[22:23], v[22:23]
    v_pk_fma_f32 v[80:81], v[80:81], v[240:241], v[240:241] op_sel:[0,1,0] op_sel_hi:[1,1,0]
    v_pk_fma_f32 v[82:83], v[82:83], v[240:241], v[240:241] op_sel:[0,1,0] op_sel_hi:[1,1,0]
    v_pk_fma_f32 v[84:85], v[84:85], v[240:241], v[240:241] op_sel:[0,1,0] op_sel_hi:[1,1,0]
    v_pk_fma_f32 v[86:87], v[86:87], v[240:241], v[240:241] op_sel:[0,1,0] op_sel_hi:[1,1,0]
    v_pk_mul_f32 v[80:81], v[80:81], v[16:17]
    v_pk_mul_f32 v[82:83], v[82:83], v[18:19]
    v_pk_mul_f32 v[84:85], v[84:85], v[20:21]
    v_pk_mul_f32 v[86:87], v[86:87], v[22:23]
    v_exp_f32 v80, v80
    v_exp_f32 v81, v81
    v_exp_f32 v82, v82
    v_exp_f32 v83, v83
    v_exp_f32 v84, v84
    v_exp_f32 v85, v85
    v_exp_f32 v86, v86
    v_exp_f32 v87, v87
    v_pk_fma_f32 v[80:81], v[80:81], v[242:243], v[242:243] op_sel:[0,0,0] op_sel_hi:[1,0,0]
    v_pk_fma_f32 v[82:83], v[82:83], v[242:243], v[242:243] op_sel:[0,0,0] op_sel_hi:[1,0,0]
    v_pk_fma_f32 v[84:85], v[84:85], v[242:243], v[242:243] op_sel:[0,0,0] op_sel_hi:[1,0,0]
    v_pk_fma_f32 v[86:87], v[86:87], v[242:243], v[242:243] op_sel:[0,0,0] op_sel_hi:[1,0,0]
    v_rcp_f32 v80, v80
    v_rcp_f32 v81, v81
    v_rcp_f32 v82, v82
    v_rcp_f32 v83, v83
    v_rcp_f32 v84, v84
    v_rcp_f32 v85, v85
    v_rcp_f32 v86, v86
    v_rcp_f32 v87, v87
    v_pk_mul_f32 v[80:81], v[80:81], v[16:17]
    v_pk_mul_f32 v[82:83], v[82:83], v[18:19]
    v_pk_mul_f32 v[84:85], v[84:85], v[20:21]
    v_pk_mul_f32 v[86:87], v[86:87], v[22:23]
    v_cvt_pk_bf16_f32 v112, v80, v81
    v_cvt_pk_bf16_f32 v113, v82, v83
    v_cvt_pk_bf16_f32 v114, v84, v85
    v_cvt_pk_bf16_f32 v115, v86, v87
    buffer_store_dwordx4 v[112:115], v9, s[24:27], s44 offen offset:0 sc1
    ds_write_b128 v12, v[112:115] offset:0
    v_pk_mul_f32 v[96:97], v[32:33], v[32:33]
    v_pk_mul_f32 v[98:99], v[34:35], v[34:35]
    v_pk_mul_f32 v[100:101], v[36:37], v[36:37]
    v_pk_mul_f32 v[102:103], v[38:39], v[38:39]
    v_pk_fma_f32 v[96:97], v[96:97], v[244:245], v[244:245] op_sel:[0,1,0] op_sel_hi:[1,1,0]
    v_pk_fma_f32 v[98:99], v[98:99], v[244:245], v[244:245] op_sel:[0,1,0] op_sel_hi:[1,1,0]
    v_pk_fma_f32 v[100:101], v[100:101], v[244:245], v[244:245] op_sel:[0,1,0] op_sel_hi:[1,1,0]
    v_pk_fma_f32 v[102:103], v[102:103], v[244:245], v[244:245] op_sel:[0,1,0] op_sel_hi:[1,1,0]
    v_pk_mul_f32 v[96:97], v[96:97], v[32:33]
    v_pk_mul_f32 v[98:99], v[98:99], v[34:35]
    v_pk_mul_f32 v[100:101], v[100:101], v[36:37]
    v_pk_mul_f32 v[102:103], v[102:103], v[38:39]
    v_exp_f32 v96, v96
    v_exp_f32 v97, v97
    v_exp_f32 v98, v98
    v_exp_f32 v99, v99
    v_exp_f32 v100, v100
    v_exp_f32 v101, v101
    v_exp_f32 v102, v102
    v_exp_f32 v103, v103
    v_pk_fma_f32 v[96:97], v[96:97], v[246:247], v[246:247] op_sel:[0,0,0] op_sel_hi:[1,0,0]
    v_pk_fma_f32 v[98:99], v[98:99], v[246:247], v[246:247] op_sel:[0,0,0] op_sel_hi:[1,0,0]
    v_pk_fma_f32 v[100:101], v[100:101], v[246:247], v[246:247] op_sel:[0,0,0] op_sel_hi:[1,0,0]
    v_pk_fma_f32 v[102:103], v[102:103], v[246:247], v[246:247] op_sel:[0,0,0] op_sel_hi:[1,0,0]
    v_rcp_f32 v96, v96
    v_rcp_f32 v97, v97
    v_rcp_f32 v98, v98
    v_rcp_f32 v99, v99
    v_rcp_f32 v100, v100
    v_rcp_f32 v101, v101
    v_rcp_f32 v102, v102
    v_rcp_f32 v103, v103
    v_pk_mul_f32 v[96:97], v[96:97], v[32:33]
    v_pk_mul_f32 v[98:99], v[98:99], v[34:35]
    v_pk_mul_f32 v[100:101], v[100:101], v[36:37]
    v_pk_mul_f32 v[102:103], v[102:103], v[38:39]
    v_cvt_pk_bf16_f32 v116, v96, v97
    v_cvt_pk_bf16_f32 v117, v98, v99
    v_cvt_pk_bf16_f32 v118, v100, v101
    v_cvt_pk_bf16_f32 v119, v102, v103
    buffer_store_dwordx4 v[116:119], v9, s[24:27], s45 offen offset:0 sc1
    ds_write_b128 v13, v[116:119] offset:0
    v_pk_mul_f32 v[80:81], v[48:49], v[48:49]
    v_pk_mul_f32 v[82:83], v[50:51], v[50:51]
    v_pk_mul_f32 v[84:85], v[52:53], v[52:53]
    v_pk_mul_f32 v[86:87], v[54:55], v[54:55]
    v_pk_fma_f32 v[80:81], v[80:81], v[240:241], v[240:241] op_sel:[0,1,0] op_sel_hi:[1,1,0]
    v_pk_fma_f32 v[82:83], v[82:83], v[240:241], v[240:241] op_sel:[0,1,0] op_sel_hi:[1,1,0]
    v_pk_fma_f32 v[84:85], v[84:85], v[240:241], v[240:241] op_sel:[0,1,0] op_sel_hi:[1,1,0]
    v_pk_fma_f32 v[86:87], v[86:87], v[240:241], v[240:241] op_sel:[0,1,0] op_sel_hi:[1,1,0]
    v_pk_mul_f32 v[80:81], v[80:81], v[48:49]
    v_pk_mul_f32 v[82:83], v[82:83], v[50:51]
    v_pk_mul_f32 v[84:85], v[84:85], v[52:53]
    v_pk_mul_f32 v[86:87], v[86:87], v[54:55]
    v_exp_f32 v80, v80
    v_exp_f32 v81, v81
    v_exp_f32 v82, v82
    v_exp_f32 v83, v83
    v_exp_f32 v84, v84
    v_exp_f32 v85, v85
    v_exp_f32 v86, v86
    v_exp_f32 v87, v87
    v_pk_fma_f32 v[80:81], v[80:81], v[242:243], v[242:243] op_sel:[0,0,0] op_sel_hi:[1,0,0]
    v_pk_fma_f32 v[82:83], v[82:83], v[242:243], v[242:243] op_sel:[0,0,0] op_sel_hi:[1,0,0]
    v_pk_fma_f32 v[84:85], v[84:85], v[242:243], v[242:243] op_sel:[0,0,0] op_sel_hi:[1,0,0]
    v_pk_fma_f32 v[86:87], v[86:87], v[242:243], v[242:243] op_sel:[0,0,0] op_sel_hi:[1,0,0]
    v_rcp_f32 v80, v80
    v_rcp_f32 v81, v81
    v_rcp_f32 v82, v82
    v_rcp_f32 v83, v83
    v_rcp_f32 v84, v84
    v_rcp_f32 v85, v85
    v_rcp_f32 v86, v86
    v_rcp_f32 v87, v87
    v_pk_mul_f32 v[80:81], v[80:81], v[48:49]
    v_pk_mul_f32 v[82:83], v[82:83], v[50:51]
    v_pk_mul_f32 v[84:85], v[84:85], v[52:53]
    v_pk_mul_f32 v[86:87], v[86:87], v[54:55]
    v_cvt_pk_bf16_f32 v120, v80, v81
    v_cvt_pk_bf16_f32 v121, v82, v83
    v_cvt_pk_bf16_f32 v122, v84, v85
    v_cvt_pk_bf16_f32 v123, v86, v87
    buffer_store_dwordx4 v[120:123], v9, s[24:27], s46 offen offset:0 sc1
    ds_write_b128 v14, v[120:123] offset:0
    v_pk_mul_f32 v[96:97], v[64:65], v[64:65]
    v_pk_mul_f32 v[98:99], v[66:67], v[66:67]
    v_pk_mul_f32 v[100:101], v[68:69], v[68:69]
    v_pk_mul_f32 v[102:103], v[70:71], v[70:71]
    v_pk_fma_f32 v[96:97], v[96:97], v[244:245], v[244:245] op_sel:[0,1,0] op_sel_hi:[1,1,0]
    v_pk_fma_f32 v[98:99], v[98:99], v[244:245], v[244:245] op_sel:[0,1,0] op_sel_hi:[1,1,0]
    v_pk_fma_f32 v[100:101], v[100:101], v[244:245], v[244:245] op_sel:[0,1,0] op_sel_hi:[1,1,0]
    v_pk_fma_f32 v[102:103], v[102:103], v[244:245], v[244:245] op_sel:[0,1,0] op_sel_hi:[1,1,0]
    v_pk_mul_f32 v[96:97], v[96:97], v[64:65]
    v_pk_mul_f32 v[98:99], v[98:99], v[66:67]
    v_pk_mul_f32 v[100:101], v[100:101], v[68:69]
    v_pk_mul_f32 v[102:103], v[102:103], v[70:71]
    v_exp_f32 v96, v96
    v_exp_f32 v97, v97
    v_exp_f32 v98, v98
    v_exp_f32 v99, v99
    v_exp_f32 v100, v100
    v_exp_f32 v101, v101
    v_exp_f32 v102, v102
    v_exp_f32 v103, v103
    v_pk_fma_f32 v[96:97], v[96:97], v[246:247], v[246:247] op_sel:[0,0,0] op_sel_hi:[1,0,0]
    v_pk_fma_f32 v[98:99], v[98:99], v[246:247], v[246:247] op_sel:[0,0,0] op_sel_hi:[1,0,0]
    v_pk_fma_f32 v[100:101], v[100:101], v[246:247], v[246:247] op_sel:[0,0,0] op_sel_hi:[1,0,0]
    v_pk_fma_f32 v[102:103], v[102:103], v[246:247], v[246:247] op_sel:[0,0,0] op_sel_hi:[1,0,0]
    v_rcp_f32 v96, v96
    v_rcp_f32 v97, v97
    v_rcp_f32 v98, v98
    v_rcp_f32 v99, v99
    v_rcp_f32 v100, v100
    v_rcp_f32 v101, v101
    v_rcp_f32 v102, v102
    v_rcp_f32 v103, v103
    v_pk_mul_f32 v[96:97], v[96:97], v[64:65]
    v_pk_mul_f32 v[98:99], v[98:99], v[66:67]
    v_pk_mul_f32 v[100:101], v[100:101], v[68:69]
    v_pk_mul_f32 v[102:103], v[102:103], v[70:71]
    v_cvt_pk_bf16_f32 v124, v96, v97
    v_cvt_pk_bf16_f32 v125, v98, v99
    v_cvt_pk_bf16_f32 v126, v100, v101
    v_cvt_pk_bf16_f32 v127, v102, v103
    buffer_store_dwordx4 v[124:127], v9, s[24:27], s47 offen offset:0 sc1
    ds_write_b128 v15, v[124:127] offset:0
    v_pk_mul_f32 v[80:81], v[24:25], v[24:25]
    v_pk_mul_f32 v[82:83], v[26:27], v[26:27]
    v_pk_mul_f32 v[84:85], v[28:29], v[28:29]
    v_pk_mul_f32 v[86:87], v[30:31], v[30:31]
    v_pk_fma_f32 v[80:81], v[80:81], v[240:241], v[240:241] op_sel:[0,1,0] op_sel_hi:[1,1,0]
    v_pk_fma_f32 v[82:83], v[82:83], v[240:241], v[240:241] op_sel:[0,1,0] op_sel_hi:[1,1,0]
    v_pk_fma_f32 v[84:85], v[84:85], v[240:241], v[240:241] op_sel:[0,1,0] op_sel_hi:[1,1,0]
    v_pk_fma_f32 v[86:87], v[86:87], v[240:241], v[240:241] op_sel:[0,1,0] op_sel_hi:[1,1,0]
    v_pk_mul_f32 v[80:81], v[80:81], v[24:25]
    v_pk_mul_f32 v[82:83], v[82:83], v[26:27]
    v_pk_mul_f32 v[84:85], v[84:85], v[28:29]
    v_pk_mul_f32 v[86:87], v[86:87], v[30:31]
    v_exp_f32 v80, v80
    v_exp_f32 v81, v81
    v_exp_f32 v82, v82
    v_exp_f32 v83, v83
    v_exp_f32 v84, v84
    v_exp_f32 v85, v85
    v_exp_f32 v86, v86
    v_exp_f32 v87, v87
    v_pk_fma_f32 v[80:81], v[80:81], v[242:243], v[242:243] op_sel:[0,0,0] op_sel_hi:[1,0,0]
    v_pk_fma_f32 v[82:83], v[82:83], v[242:243], v[242:243] op_sel:[0,0,0] op_sel_hi:[1,0,0]
    v_pk_fma_f32 v[84:85], v[84:85], v[242:243], v[242:243] op_sel:[0,0,0] op_sel_hi:[1,0,0]
    v_pk_fma_f32 v[86:87], v[86:87], v[242:243], v[242:243] op_sel:[0,0,0] op_sel_hi:[1,0,0]
    v_rcp_f32 v80, v80
    v_rcp_f32 v81, v81
    v_rcp_f32 v82, v82
    v_rcp_f32 v83, v83
    v_rcp_f32 v84, v84
    v_rcp_f32 v85, v85
    v_rcp_f32 v86, v86
    v_rcp_f32 v87, v87
    v_pk_mul_f32 v[80:81], v[80:81], v[24:25]
    v_pk_mul_f32 v[82:83], v[82:83], v[26:27]
    v_pk_mul_f32 v[84:85], v[84:85], v[28:29]
    v_pk_mul_f32 v[86:87], v[86:87], v[30:31]
    v_cvt_pk_bf16_f32 v112, v80, v81
    v_cvt_pk_bf16_f32 v113, v82, v83
    v_cvt_pk_bf16_f32 v114, v84, v85
    v_cvt_pk_bf16_f32 v115, v86, v87
    buffer_store_dwordx4 v[112:115], v9, s[24:27], s44 offen offset:2048 sc1
    ds_write_b128 v12, v[112:115] offset:32768
    v_pk_mul_f32 v[96:97], v[40:41], v[40:41]
    v_pk_mul_f32 v[98:99], v[42:43], v[42:43]
    v_pk_mul_f32 v[100:101], v[44:45], v[44:45]
    v_pk_mul_f32 v[102:103], v[46:47], v[46:47]
    v_pk_fma_f32 v[96:97], v[96:97], v[244:245], v[244:245] op_sel:[0,1,0] op_sel_hi:[1,1,0]
    v_pk_fma_f32 v[98:99], v[98:99], v[244:245], v[244:245] op_sel:[0,1,0] op_sel_hi:[1,1,0]
    v_pk_fma_f32 v[100:101], v[100:101], v[244:245], v[244:245] op_sel:[0,1,0] op_sel_hi:[1,1,0]
    v_pk_fma_f32 v[102:103], v[102:103], v[244:245], v[244:245] op_sel:[0,1,0] op_sel_hi:[1,1,0]
    v_pk_mul_f32 v[96:97], v[96:97], v[40:41]
    v_pk_mul_f32 v[98:99], v[98:99], v[42:43]
    v_pk_mul_f32 v[100:101], v[100:101], v[44:45]
    v_pk_mul_f32 v[102:103], v[102:103], v[46:47]
    v_exp_f32 v96, v96
    v_exp_f32 v97, v97
    v_exp_f32 v98, v98
    v_exp_f32 v99, v99
    v_exp_f32 v100, v100
    v_exp_f32 v101, v101
    v_exp_f32 v102, v102
    v_exp_f32 v103, v103
    v_pk_fma_f32 v[96:97], v[96:97], v[246:247], v[246:247] op_sel:[0,0,0] op_sel_hi:[1,0,0]
    v_pk_fma_f32 v[98:99], v[98:99], v[246:247], v[246:247] op_sel:[0,0,0] op_sel_hi:[1,0,0]
    v_pk_fma_f32 v[100:101], v[100:101], v[246:247], v[246:247] op_sel:[0,0,0] op_sel_hi:[1,0,0]
    v_pk_fma_f32 v[102:103], v[102:103], v[246:247], v[246:247] op_sel:[0,0,0] op_sel_hi:[1,0,0]
    v_rcp_f32 v96, v96
    v_rcp_f32 v97, v97
    v_rcp_f32 v98, v98
    v_rcp_f32 v99, v99
    v_rcp_f32 v100, v100
    v_rcp_f32 v101, v101
    v_rcp_f32 v102, v102
    v_rcp_f32 v103, v103
    v_pk_mul_f32 v[96:97], v[96:97], v[40:41]
    v_pk_mul_f32 v[98:99], v[98:99], v[42:43]
    v_pk_mul_f32 v[100:101], v[100:101], v[44:45]
    v_pk_mul_f32 v[102:103], v[102:103], v[46:47]
    v_cvt_pk_bf16_f32 v116, v96, v97
    v_cvt_pk_bf16_f32 v117, v98, v99
    v_cvt_pk_bf16_f32 v118, v100, v101
    v_cvt_pk_bf16_f32 v119, v102, v103
    buffer_store_dwordx4 v[116:119], v9, s[24:27], s45 offen offset:2048 sc1
    ds_write_b128 v13, v[116:119] offset:32768
    v_pk_mul_f32 v[80:81], v[56:57], v[56:57]
    v_pk_mul_f32 v[82:83], v[58:59], v[58:59]
    v_pk_mul_f32 v[84:85], v[60:61], v[60:61]
    v_pk_mul_f32 v[86:87], v[62:63], v[62:63]
    v_pk_fma_f32 v[80:81], v[80:81], v[240:241], v[240:241] op_sel:[0,1,0] op_sel_hi:[1,1,0]
    v_pk_fma_f32 v[82:83], v[82:83], v[240:241], v[240:241] op_sel:[0,1,0] op_sel_hi:[1,1,0]
    v_pk_fma_f32 v[84:85], v[84:85], v[240:241], v[240:241] op_sel:[0,1,0] op_sel_hi:[1,1,0]
    v_pk_fma_f32 v[86:87], v[86:87], v[240:241], v[240:241] op_sel:[0,1,0] op_sel_hi:[1,1,0]
    v_pk_mul_f32 v[80:81], v[80:81], v[56:57]
    v_pk_mul_f32 v[82:83], v[82:83], v[58:59]
    v_pk_mul_f32 v[84:85], v[84:85], v[60:61]
    v_pk_mul_f32 v[86:87], v[86:87], v[62:63]
    v_exp_f32 v80, v80
    v_exp_f32 v81, v81
    v_exp_f32 v82, v82
    v_exp_f32 v83, v83
    v_exp_f32 v84, v84
    v_exp_f32 v85, v85
    v_exp_f32 v86, v86
    v_exp_f32 v87, v87
    v_pk_fma_f32 v[80:81], v[80:81], v[242:243], v[242:243] op_sel:[0,0,0] op_sel_hi:[1,0,0]
    v_pk_fma_f32 v[82:83], v[82:83], v[242:243], v[242:243] op_sel:[0,0,0] op_sel_hi:[1,0,0]
    v_pk_fma_f32 v[84:85], v[84:85], v[242:243], v[242:243] op_sel:[0,0,0] op_sel_hi:[1,0,0]
    v_pk_fma_f32 v[86:87], v[86:87], v[242:243], v[242:243] op_sel:[0,0,0] op_sel_hi:[1,0,0]
    v_rcp_f32 v80, v80
    v_rcp_f32 v81, v81
    v_rcp_f32 v82, v82
    v_rcp_f32 v83, v83
    v_rcp_f32 v84, v84
    v_rcp_f32 v85, v85
    v_rcp_f32 v86, v86
    v_rcp_f32 v87, v87
    v_pk_mul_f32 v[80:81], v[80:81], v[56:57]
    v_pk_mul_f32 v[82:83], v[82:83], v[58:59]
    v_pk_mul_f32 v[84:85], v[84:85], v[60:61]
    v_pk_mul_f32 v[86:87], v[86:87], v[62:63]
    v_cvt_pk_bf16_f32 v120, v80, v81
    v_cvt_pk_bf16_f32 v121, v82, v83
    v_cvt_pk_bf16_f32 v122, v84, v85
    v_cvt_pk_bf16_f32 v123, v86, v87
    buffer_store_dwordx4 v[120:123], v9, s[24:27], s46 offen offset:2048 sc1
    ds_write_b128 v14, v[120:123] offset:32768
    s_waitcnt vmcnt(3)
    s_barrier
    s_cmp_lg_u32 s28, 0
    s_cbranch_scc1 Lg1_nf
    s_mov_b64 exec, 0xffff
    buffer_store_dwordx2 v[254:255], v11, s[52:55], s48 offen offset:0 sc1
    s_mov_b64 exec, -1
Lg1_nf:
    v_pk_mul_f32 v[96:97], v[72:73], v[72:73]
    v_pk_mul_f32 v[98:99], v[74:75], v[74:75]
    v_pk_mul_f32 v[100:101], v[76:77], v[76:77]
    v_pk_mul_f32 v[102:103], v[78:79], v[78:79]
    v_pk_fma_f32 v[96:97], v[96:97], v[244:245], v[244:245] op_sel:[0,1,0] op_sel_hi:[1,1,0]
    v_pk_fma_f32 v[98:99], v[98:99], v[244:245], v[244:245] op_sel:[0,1,0] op_sel_hi:[1,1,0]
    v_pk_fma_f32 v[100:101], v[100:101], v[244:245], v[244:245] op_sel:[0,1,0] op_sel_hi:[1,1,0]
    v_pk_fma_f32 v[102:103], v[102:103], v[244:245], v[244:245] op_sel:[0,1,0] op_sel_hi:[1,1,0]
    v_pk_mul_f32 v[96:97], v[96:97], v[72:73]
    v_pk_mul_f32 v[98:99], v[98:99], v[74:75]
    v_pk_mul_f32 v[100:101], v[100:101], v[76:77]
    v_pk_mul_f32 v[102:103], v[102:103], v[78:79]
    v_exp_f32 v96, v96
    v_exp_f32 v97, v97
    v_exp_f32 v98, v98
    v_exp_f32 v99, v99
    v_exp_f32 v100, v100
    v_exp_f32 v101, v101
    v_exp_f32 v102, v102
    v_exp_f32 v103, v103
    v_pk_fma_f32 v[96:97], v[96:97], v[246:247], v[246:247] op_sel:[0,0,0] op_sel_hi:[1,0,0]
    v_pk_fma_f32 v[98:99], v[98:99], v[246:247], v[246:247] op_sel:[0,0,0] op_sel_hi:[1,0,0]
    v_pk_fma_f32 v[100:101], v[100:101], v[246:247], v[246:247] op_sel:[0,0,0] op_sel_hi:[1,0,0]
    v_pk_fma_f32 v[102:103], v[102:103], v[246:247], v[246:247] op_sel:[0,0,0] op_sel_hi:[1,0,0]
    v_rcp_f32 v96, v96
    v_rcp_f32 v97, v97
    v_rcp_f32 v98, v98
    v_rcp_f32 v99, v99
    v_rcp_f32 v100, v100
    v_rcp_f32 v101, v101
    v_rcp_f32 v102, v102
    v_rcp_f32 v103, v103
    v_pk_mul_f32 v[96:97], v[96:97], v[72:73]
    v_pk_mul_f32 v[98:99], v[98:99], v[74:75]
    v_pk_mul_f32 v[100:101], v[100:101], v[76:77]
    v_pk_mul_f32 v[102:103], v[102:103], v[78:79]
    v_cvt_pk_bf16_f32 v124, v96, v97
    v_cvt_pk_bf16_f32 v125, v98, v99
    v_cvt_pk_bf16_f32 v126, v100, v101
    v_cvt_pk_bf16_f32 v127, v102, v103
    buffer_store_dwordx4 v[124:127], v9, s[24:27], s47 offen offset:2048 sc1
    ds_write_b128 v15, v[124:127] offset:32768
    s_cmp_lt_u32 s32, 20
    s_cbranch_scc1 Lg2c
    s_mov_b32 s51, 1
    s_add_u32 s42, s48, 128
    s_branch Lp2
Lg2c:
    s_waitcnt lgkmcnt(0)
    s_barrier
    ds_read_b64_tr_b16 v[88:89], v249 offset:16384
    ds_read_b64_tr_b16 v[90:91], v249 offset:18432
    ds_read_b64_tr_b16 v[92:93], v250 offset:16384
    ds_read_b64_tr_b16 v[94:95], v250 offset:18432
    ds_read_b128 v[80:83], v248 offset:0
    ds_read_b128 v[84:87], v248 offset:4096
    ds_read_b64_tr_b16 v[104:105], v249 offset:20480
    ds_read_b64_tr_b16 v[106:107], v249 offset:22528
    ds_read_b64_tr_b16 v[108:109], v250 offset:20480
    ds_read_b64_tr_b16 v[110:111], v250 offset:22528
    ds_read_b128 v[96:99], v248 offset:1024
    ds_read_b128 v[100:103], v248 offset:5120
    ds_read_b64_tr_b16 v[120:121], v249 offset:24576
    ds_read_b64_tr_b16 v[122:123], v249 offset:26624
    ds_read_b64_tr_b16 v[124:125], v250 offset:24576
    ds_read_b64_tr_b16 v[126:127], v250 offset:26624
    ds_read_b128 v[112:115], v248 offset:2048
    ds_read_b128 v[116:119], v248 offset:6144
    ds_read_b64_tr_b16 v[136:137], v249 offset:28672
    ds_read_b64_tr_b16 v[138:139], v249 offset:30720
    ds_read_b64_tr_b16 v[140:141], v250 offset:28672
    ds_read_b64_tr_b16 v[142:143], v250 offset:30720
    ds_read_b128 v[128:131], v248 offset:3072
    ds_read_b128 v[132:135], v248 offset:7168
    s_waitcnt lgkmcnt(0)
    v_mfma_f32_32x32x16_bf16 v[16:31], v[80:83], v[88:91], 0
    ds_read_b64_tr_b16 v[152:153], v249 offset:49152
    ds_read_b64_tr_b16 v[154:155], v249 offset:51200
    v_mfma_f32_32x32x16_bf16 v[32:47], v[84:87], v[88:91], 0
    ds_read_b64_tr_b16 v[156:157], v250 offset:49152
    ds_read_b64_tr_b16 v[158:159], v250 offset:51200
    v_mfma_f32_32x32x16_bf16 v[48:63], v[80:83], v[92:95], 0
    ds_read_b128 v[144:147], v248 offset:32768
    ds_read_b128 v[148:151], v248 offset:36864
    ds_read_b64_tr_b16 v[168:169], v249 offset:53248
    v_mfma_f32_32x32x16_bf16 v[64:79], v[84:87], v[92:95], 0
    ds_read_b64_tr_b16 v[170:171], v249 offset:55296
    ds_read_b64_tr_b16 v[172:173], v250 offset:53248
    v_mfma_f32_32x32x16_bf16 v[16:31], v[96:99], v[104:107], v[16:31]
    ds_read_b64_tr_b16 v[174:175], v250 offset:55296
    ds_read_b128 v[160:163], v248 offset:33792
    ds_read_b128 v[164:167], v248 offset:37888
    v_mfma_f32_32x32x16_bf16 v[32:47], v[100:103], v[104:107], v[32:47]
    ds_read_b64_tr_b16 v[184:185], v249 offset:57344
    ds_read_b64_tr_b16 v[186:187], v249 offset:59392
    v_mfma_f32_32x32x16_bf16 v[48:63], v[96:99], v[108:111], v[48:63]
    ds_read_b64_tr_b16 v[188:189], v250 offset:57344
    ds_read_b64_tr_b16 v[190:191], v250 offset:59392
    v_mfma_f32_32x32x16_bf16 v[64:79], v[100:103], v[108:111], v[64:79]
    ds_read_b128 v[176:179], v248 offset:34816
    ds_read_b128 v[180:183], v248 offset:38912
    ds_read_b64_tr_b16 v[200:201], v249 offset:61440
    v_mfma_f32_32x32x16_bf16 v[16:31], v[112:115], v[120:123], v[16:31]
    ds_read_b64_tr_b16 v[202:203], v249 offset:63488
    ds_read_b64_tr_b16 v[204:205], v250 offset:61440
    v_mfma_f32_32x32x16_bf16 v[32:47], v[116:119], v[120:123], v[32:47]
    ds_read_b64_tr_b16 v[206:207], v250 offset:63488
    ds_read_b128 v[192:195], v248 offset:35840
    ds_read_b128 v[196:199], v248 offset:39936
    v_mfma_f32_32x32x16_bf16 v[48:63], v[112:115], v[124:127], v[48:63]
    v_mfma_f32_32x32x16_bf16 v[64:79], v[116:119], v[124:127], v[64:79]
    v_mfma_f32_32x32x16_bf16 v[16:31], v[128:131], v[136:139], v[16:31]
    v_mfma_f32_32x32x16_bf16 v[32:47], v[132:135], v[136:139], v[32:47]
    v_mfma_f32_32x32x16_bf16 v[48:63], v[128:131], v[140:143], v[48:63]
    v_mfma_f32_32x32x16_bf16 v[64:79], v[132:135], v[140:143], v[64:79]
    s_waitcnt vmcnt(0) lgkmcnt(0)
    s_barrier
    s_cmp_lg_u32 s28, 0
    s_cbranch_scc1 Lg2_nf
    s_mov_b64 exec, 0xffff
    buffer_store_dwordx2 v[254:255], v11, s[52:55], s48 offen offset:128 sc1
    s_mov_b64 exec, -1
Lg2_nf:
    v_mfma_f32_32x32x16_bf16 v[16:31], v[144:147], v[152:155], v[16:31]
    v_mfma_f32_32x32x16_bf16 v[32:47], v[148:151], v[152:155], v[32:47]
    v_mov_b32 v5, 0x3f80
    v_mfma_f32_32x32x16_bf16 v[48:63], v[144:147], v[156:159], v[48:63]
    v_cndmask_b32 v224, 0, v5, vcc
    v_mfma_f32_32x32x16_bf16 v[64:79], v[148:151], v[156:159], v[64:79]
    v_mov_b32 v225, 0
    v_mfma_f32_32x32x16_bf16 v[16:31], v[160:163], v[168:171], v[16:31]
    v_mov_b32 v228, v222
    v_mfma_f32_32x32x16_bf16 v[32:47], v[164:167], v[168:171], v[32:47]
    v_mov_b32 v229, 0
    v_mfma_f32_32x32x16_bf16 v[48:63], v[160:163], v[172:175], v[48:63]
    v_mov_b32 v232, v223
    v_mfma_f32_32x32x16_bf16 v[64:79], v[164:167], v[172:175], v[64:79]
    v_mov_b32 v233, 0
    v_mfma_f32_32x32x16_bf16 v[16:31], v[224:227], v[228:231], v[16:31]
    v_mfma_f32_32x32x16_bf16 v[32:47], v[224:227], v[228:231], v[32:47]
    v_mfma_f32_32x32x16_bf16 v[48:63], v[224:227], v[232:235], v[48:63]
    v_mfma_f32_32x32x16_bf16 v[64:79], v[224:227], v[232:235], v[64:79]
    v_mfma_f32_32x32x16_bf16 v[16:31], v[176:179], v[184:187], v[16:31]
    v_mfma_f32_32x32x16_bf16 v[32:47], v[180:183], v[184:187], v[32:47]
    v_mfma_f32_32x32x16_bf16 v[48:63], v[176:179], v[188:191], v[48:63]
    v_mfma_f32_32x32x16_bf16 v[64:79], v[180:183], v[188:191], v[64:79]
    s_barrier
    v_mfma_f32_32x32x16_bf16 v[16:31], v[192:195], v[200:203], v[16:31]
    v_xor_b32 v248, 0x10000, v248
    v_xor_b32 v249, 0x10000, v249
    v_xor_b32 v250, 0x10000, v250
    ds_read_b64_tr_b16 v[88:89], v249 offset:16384
    ds_read_b64_tr_b16 v[90:91], v249 offset:18432
    ds_read_b64_tr_b16 v[92:93], v250 offset:16384
    v_mfma_f32_32x32x16_bf16 v[32:47], v[196:199], v[200:203], v[32:47]
    ds_read_b64_tr_b16 v[94:95], v250 offset:18432
    ds_read_b128 v[80:83], v248 offset:0
    ds_read_b128 v[84:87], v248 offset:4096
    ds_read_b64_tr_b16 v[104:105], v249 offset:20480
    ds_read_b64_tr_b16 v[106:107], v249 offset:22528
    ds_read_b64_tr_b16 v[108:109], v250 offset:20480
    ds_read_b64_tr_b16 v[110:111], v250 offset:22528
    v_mfma_f32_32x32x16_bf16 v[48:63], v[192:195], v[204:207], v[48:63]
    ds_read_b128 v[96:99], v248 offset:1024
    ds_read_b128 v[100:103], v248 offset:5120
    ds_read_b64_tr_b16 v[120:121], v249 offset:24576
    ds_read_b64_tr_b16 v[122:123], v249 offset:26624
    ds_read_b64_tr_b16 v[124:125], v250 offset:24576
    ds_read_b64_tr_b16 v[126:127], v250 offset:26624
    ds_read_b128 v[112:115], v248 offset:2048
    v_mfma_f32_32x32x16_bf16 v[64:79], v[196:199], v[204:207], v[64:79]
    ds_read_b128 v[116:119], v248 offset:6144
    ds_read_b64_tr_b16 v[136:137], v249 offset:28672
    ds_read_b64_tr_b16 v[138:139], v249 offset:30720
    ds_read_b64_tr_b16 v[140:141], v250 offset:28672
    ds_read_b64_tr_b16 v[142:143], v250 offset:30720
    ds_read_b128 v[128:131], v248 offset:3072
    ds_read_b128 v[132:135], v248 offset:7168
    s_waitcnt lgkmcnt(0)
    s_barrier
    v_mfma_f32_32x32x16_bf16 v[16:31], v[80:83], v[88:91], v[16:31]
    ds_read_b64_tr_b16 v[152:153], v249 offset:49152
    ds_read_b64_tr_b16 v[154:155], v249 offset:51200
    v_mfma_f32_32x32x16_bf16 v[32:47], v[84:87], v[88:91], v[32:47]
    ds_read_b64_tr_b16 v[156:157], v250 offset:49152
    ds_read_b64_tr_b16 v[158:159], v250 offset:51200
    v_mfma_f32_32x32x16_bf16 v[48:63], v[80:83], v[92:95], v[48:63]
    ds_read_b128 v[144:147], v248 offset:32768
    ds_read_b128 v[148:151], v248 offset:36864
    ds_read_b64_tr_b16 v[168:169], v249 offset:53248
    v_mfma_f32_32x32x16_bf16 v[64:79], v[84:87], v[92:95], v[64:79]
    ds_read_b64_tr_b16 v[170:171], v249 offset:55296
    ds_read_b64_tr_b16 v[172:173], v250 offset:53248
    v_mfma_f32_32x32x16_bf16 v[16:31], v[96:99], v[104:107], v[16:31]
    ds_read_b64_tr_b16 v[174:175], v250 offset:55296
    ds_read_b128 v[160:163], v248 offset:33792
    ds_read_b128 v[164:167], v248 offset:37888
    v_mfma_f32_32x32x16_bf16 v[32:47], v[100:103], v[104:107], v[32:47]
    ds_read_b64_tr_b16 v[184:185], v249 offset:57344
    ds_read_b64_tr_b16 v[186:187], v249 offset:59392
    v_mfma_f32_32x32x16_bf16 v[48:63], v[96:99], v[108:111], v[48:63]
    ds_read_b64_tr_b16 v[188:189], v250 offset:57344
    ds_read_b64_tr_b16 v[190:191], v250 offset:59392
    v_mfma_f32_32x32x16_bf16 v[64:79], v[100:103], v[108:111], v[64:79]
    ds_read_b128 v[176:179], v248 offset:34816
    ds_read_b128 v[180:183], v248 offset:38912
    ds_read_b64_tr_b16 v[200:201], v249 offset:61440
    v_mfma_f32_32x32x16_bf16 v[16:31], v[112:115], v[120:123], v[16:31]
    ds_read_b64_tr_b16 v[202:203], v249 offset:63488
    ds_read_b64_tr_b16 v[204:205], v250 offset:61440
    v_mfma_f32_32x32x16_bf16 v[32:47], v[116:119], v[120:123], v[32:47]
    ds_read_b64_tr_b16 v[206:207], v250 offset:63488
    ds_read_b128 v[192:195], v248 offset:35840
    ds_read_b128 v[196:199], v248 offset:39936
    v_mfma_f32_32x32x16_bf16 v[48:63], v[112:115], v[124:127], v[48:63]
    v_mfma_f32_32x32x16_bf16 v[64:79], v[116:119], v[124:127], v[64:79]
    v_mfma_f32_32x32x16_bf16 v[16:31], v[128:131], v[136:139], v[16:31]
    s_waitcnt lgkmcnt(0)
    s_barrier
    v_mfma_f32_32x32x16_bf16 v[32:47], v[132:135], v[136:139], v[32:47]
    v_mfma_f32_32x32x16_bf16 v[48:63], v[128:131], v[140:143], v[48:63]
    v_mfma_f32_32x32x16_bf16 v[64:79], v[132:135], v[140:143], v[64:79]
    v_mfma_f32_32x32x16_bf16 v[16:31], v[144:147], v[152:155], v[16:31]
    v_xor_b32 v248, 0x10000, v248
    v_xor_b32 v249, 0x10000, v249
    v_mfma_f32_32x32x16_bf16 v[32:47], v[148:151], v[152:155], v[32:47]
    v_xor_b32 v250, 0x10000, v250
    ds_read_b64_tr_b16 v[88:89], v249 offset:16384
    ds_read_b64_tr_b16 v[90:91], v249 offset:18432
    v_mfma_f32_32x32x16_bf16 v[48:63], v[144:147], v[156:159], v[48:63]
    ds_read_b64_tr_b16 v[92:93], v250 offset:16384
    ds_read_b64_tr_b16 v[94:95], v250 offset:18432
    ds_read_b128 v[80:83], v248 offset:0
    v_mfma_f32_32x32x16_bf16 v[64:79], v[148:151], v[156:159], v[64:79]
    ds_read_b128 v[84:87], v248 offset:4096
    ds_read_b64_tr_b16 v[104:105], v249 offset:20480
    v_mfma_f32_32x32x16_bf16 v[16:31], v[160:163], v[168:171], v[16:31]
    ds_read_b64_tr_b16 v[106:107], v249 offset:22528
    ds_read_b64_tr_b16 v[108:109], v250 offset:20480
    ds_read_b64_tr_b16 v[110:111], v250 offset:22528
    v_mfma_f32_32x32x16_bf16 v[32:47], v[164:167], v[168:171], v[32:47]
    ds_read_b128 v[96:99], v248 offset:1024
    ds_read_b128 v[100:103], v248 offset:5120
    ds_read_b64_tr_b16 v[120:121], v249 offset:24576
    v_mfma_f32_32x32x16_bf16 v[48:63], v[160:163], v[172:175], v[48:63]
    ds_read_b64_tr_b16 v[122:123], v249 offset:26624
    ds_read_b64_tr_b16 v[124:125], v250 offset:24576
    v_mfma_f32_32x32x16_bf16 v[64:79], v[164:167], v[172:175], v[64:79]
    ds_read_b64_tr_b16 v[126:127], v250 offset:26624
    ds_read_b128 v[112:115], v248 offset:2048
    ds_read_b128 v[116:119], v248 offset:6144
    v_mfma_f32_32x32x16_bf16 v[16:31], v[176:179], v[184:187], v[16:31]
    ds_read_b64_tr_b16 v[136:137], v249 offset:28672
    ds_read_b64_tr_b16 v[138:139], v249 offset:30720
    ds_read_b64_tr_b16 v[140:141], v250 offset:28672
    v_mfma_f32_32x32x16_bf16 v[32:47], v[180:183], v[184:187], v[32:47]
    ds_read_b64_tr_b16 v[142:143], v250 offset:30720
    ds_read_b128 v[128:131], v248 offset:3072
    ds_read_b128 v[132:135], v248 offset:7168
    v_mfma_f32_32x32x16_bf16 v[48:63], v[176:179], v[188:191], v[48:63]
    v_mfma_f32_32x32x16_bf16 v[64:79], v[180:183], v[188:191], v[64:79]
    v_mfma_f32_32x32x16_bf16 v[16:31], v[192:195], v[200:203], v[16:31]
    s_waitcnt lgkmcnt(0)
    s_barrier
    v_mfma_f32_32x32x16_bf16 v[32:47], v[196:199], v[200:203], v[32:47]
    v_mfma_f32_32x32x16_bf16 v[48:63], v[192:195], v[204:207], v[48:63]
    v_mfma_f32_32x32x16_bf16 v[64:79], v[196:199], v[204:207], v[64:79]
    v_mfma_f32_32x32x16_bf16 v[16:31], v[80:83], v[88:91], v[16:31]
    ds_read_b64_tr_b16 v[152:153], v249 offset:49152
    ds_read_b64_tr_b16 v[154:155], v249 offset:51200
    v_mfma_f32_32x32x16_bf16 v[32:47], v[84:87], v[88:91], v[32:47]
    ds_read_b64_tr_b16 v[156:157], v250 offset:49152
    ds_read_b64_tr_b16 v[158:159], v250 offset:51200
    v_mfma_f32_32x32x16_bf16 v[48:63], v[80:83], v[92:95], v[48:63]
    ds_read_b128 v[144:147], v248 offset:32768
    ds_read_b128 v[148:151], v248 offset:36864
    ds_read_b64_tr_b16 v[168:169], v249 offset:53248
    v_mfma_f32_32x32x16_bf16 v[64:79], v[84:87], v[92:95], v[64:79]
    ds_read_b64_tr_b16 v[170:171], v249 offset:55296
    ds_read_b64_tr_b16 v[172:173], v250 offset:53248
    v_mfma_f32_32x32x16_bf16 v[16:31], v[96:99], v[104:107], v[16:31]
    ds_read_b64_tr_b16 v[174:175], v250 offset:55296
    ds_read_b128 v[160:163], v248 offset:33792
    ds_read_b128 v[164:167], v248 offset:37888
    v_mfma_f32_32x32x16_bf16 v[32:47], v[100:103], v[104:107], v[32:47]
    ds_read_b64_tr_b16 v[184:185], v249 offset:57344
    ds_read_b64_tr_b16 v[186:187], v249 offset:59392
    v_mfma_f32_32x32x16_bf16 v[48:63], v[96:99], v[108:111], v[48:63]
    ds_read_b64_tr_b16 v[188:189], v250 offset:57344
    ds_read_b64_tr_b16 v[190:191], v250 offset:59392
    v_mfma_f32_32x32x16_bf16 v[64:79], v[100:103], v[108:111], v[64:79]
    ds_read_b128 v[176:179], v248 offset:34816
    ds_read_b128 v[180:183], v248 offset:38912
    ds_read_b64_tr_b16 v[200:201], v249 offset:61440
    v_mfma_f32_32x32x16_bf16 v[16:31], v[112:115], v[120:123], v[16:31]
    ds_read_b64_tr_b16 v[202:203], v249 offset:63488
    ds_read_b64_tr_b16 v[204:205], v250 offset:61440
    v_mfma_f32_32x32x16_bf16 v[32:47], v[116:119], v[120:123], v[32:47]
    ds_read_b64_tr_b16 v[206:207], v250 offset:63488
    ds_read_b128 v[192:195], v248 offset:35840
    ds_read_b128 v[196:199], v248 offset:39936
    v_mfma_f32_32x32x16_bf16 v[48:63], v[112:115], v[124:127], v[48:63]
    v_mfma_f32_32x32x16_bf16 v[64:79], v[116:119], v[124:127], v[64:79]
    v_mfma_f32_32x32x16_bf16 v[16:31], v[128:131], v[136:139], v[16:31]
    s_waitcnt lgkmcnt(0)
    s_barrier
    v_mfma_f32_32x32x16_bf16 v[32:47], v[132:135], v[136:139], v[32:47]
    v_mfma_f32_32x32x16_bf16 v[48:63], v[128:131], v[140:143], v[48:63]
    v_mfma_f32_32x32x16_bf16 v[64:79], v[132:135], v[140:143], v[64:79]
    v_mfma_f32_32x32x16_bf16 v[16:31], v[144:147], v[152:155], v[16:31]
    v_xor_b32 v248, 0x10000, v248
    v_xor_b32 v249, 0x10000, v249
    v_mfma_f32_32x32x16_bf16 v[32:47], v[148:151], v[152:155], v[32:47]
    v_xor_b32 v250, 0x10000, v250
    ds_read_b64_tr_b16 v[88:89], v249 offset:16384
    ds_read_b64_tr_b16 v[90:91], v249 offset:18432
    v_mfma_f32_32x32x16_bf16 v[48:63], v[144:147], v[156:159], v[48:63]
    ds_read_b64_tr_b16 v[92:93], v250 offset:16384
    ds_read_b64_tr_b16 v[94:95], v250 offset:18432
    ds_read_b128 v[80:83], v248 offset:0
    v_mfma_f32_32x32x16_bf16 v[64:79], v[148:151], v[156:159], v[64:79]
    ds_read_b128 v[84:87], v248 offset:4096
    ds_read_b64_tr_b16 v[104:105], v249 offset:20480
    v_mfma_f32_32x32x16_bf16 v[16:31], v[160:163], v[168:171], v[16:31]
    ds_read_b64_tr_b16 v[106:107], v249 offset:22528
    ds_read_b64_tr_b16 v[108:109], v250 offset:20480
    ds_read_b64_tr_b16 v[110:111], v250 offset:22528
    v_mfma_f32_32x32x16_bf16 v[32:47], v[164:167], v[168:171], v[32:47]
    ds_read_b128 v[96:99], v248 offset:1024
    ds_read_b128 v[100:103], v248 offset:5120
    ds_read_b64_tr_b16 v[120:121], v249 offset:24576
    v_mfma_f32_32x32x16_bf16 v[48:63], v[160:163], v[172:175], v[48:63]
    ds_read_b64_tr_b16 v[122:123], v249 offset:26624
    ds_read_b64_tr_b16 v[124:125], v250 offset:24576
    v_mfma_f32_32x32x16_bf16 v[64:79], v[164:167], v[172:175], v[64:79]
    ds_read_b64_tr_b16 v[126:127], v250 offset:26624
    ds_read_b128 v[112:115], v248 offset:2048
    ds_read_b128 v[116:119], v248 offset:6144
    v_mfma_f32_32x32x16_bf16 v[16:31], v[176:179], v[184:187], v[16:31]
    ds_read_b64_tr_b16 v[136:137], v249 offset:28672
    ds_read_b64_tr_b16 v[138:139], v249 offset:30720
    ds_read_b64_tr_b16 v[140:141], v250 offset:28672
    v_mfma_f32_32x32x16_bf16 v[32:47], v[180:183], v[184:187], v[32:47]
    ds_read_b64_tr_b16 v[142:143], v250 offset:30720
    ds_read_b128 v[128:131], v248 offset:3072
    ds_read_b128 v[132:135], v248 offset:7168
    v_mfma_f32_32x32x16_bf16 v[48:63], v[176:179], v[188:191], v[48:63]
    v_mfma_f32_32x32x16_bf16 v[64:79], v[180:183], v[188:191], v[64:79]
    v_mfma_f32_32x32x16_bf16 v[16:31], v[192:195], v[200:203], v[16:31]
    s_waitcnt lgkmcnt(0)
    s_barrier
    v_mfma_f32_32x32x16_bf16 v[32:47], v[196:199], v[200:203], v[32:47]
    v_mfma_f32_32x32x16_bf16 v[48:63], v[192:195], v[204:207], v[48:63]
    v_mfma_f32_32x32x16_bf16 v[64:79], v[196:199], v[204:207], v[64:79]
    v_mfma_f32_32x32x16_bf16 v[16:31], v[80:83], v[88:91], v[16:31]
    ds_read_b64_tr_b16 v[152:153], v249 offset:49152
    ds_read_b64_tr_b16 v[154:155], v249 offset:51200
    v_mfma_f32_32x32x16_bf16 v[32:47], v[84:87], v[88:91], v[32:47]
    ds_read_b64_tr_b16 v[156:157], v250 offset:49152
    ds_read_b64_tr_b16 v[158:159], v250 offset:51200
    v_mfma_f32_32x32x16_bf16 v[48:63], v[80:83], v[92:95], v[48:63]
    ds_read_b128 v[144:147], v248 offset:32768
    ds_read_b128 v[148:151], v248 offset:36864
    ds_read_b64_tr_b16 v[168:169], v249 offset:53248
    v_mfma_f32_32x32x16_bf16 v[64:79], v[84:87], v[92:95], v[64:79]
    ds_read_b64_tr_b16 v[170:171], v249 offset:55296
    ds_read_b64_tr_b16 v[172:173], v250 offset:53248
    v_mfma_f32_32x32x16_bf16 v[16:31], v[96:99], v[104:107], v[16:31]
    ds_read_b64_tr_b16 v[174:175], v250 offset:55296
    ds_read_b128 v[160:163], v248 offset:33792
    ds_read_b128 v[164:167], v248 offset:37888
    v_mfma_f32_32x32x16_bf16 v[32:47], v[100:103], v[104:107], v[32:47]
    ds_read_b64_tr_b16 v[184:185], v249 offset:57344
    ds_read_b64_tr_b16 v[186:187], v249 offset:59392
    v_mfma_f32_32x32x16_bf16 v[48:63], v[96:99], v[108:111], v[48:63]
    ds_read_b64_tr_b16 v[188:189], v250 offset:57344
    ds_read_b64_tr_b16 v[190:191], v250 offset:59392
    v_mfma_f32_32x32x16_bf16 v[64:79], v[100:103], v[108:111], v[64:79]
    ds_read_b128 v[176:179], v248 offset:34816
    ds_read_b128 v[180:183], v248 offset:38912
    ds_read_b64_tr_b16 v[200:201], v249 offset:61440
    v_mfma_f32_32x32x16_bf16 v[16:31], v[112:115], v[120:123], v[16:31]
    ds_read_b64_tr_b16 v[202:203], v249 offset:63488
    ds_read_b64_tr_b16 v[204:205], v250 offset:61440
    v_mfma_f32_32x32x16_bf16 v[32:47], v[116:119], v[120:123], v[32:47]
    ds_read_b64_tr_b16 v[206:207], v250 offset:63488
    ds_read_b128 v[192:195], v248 offset:35840
    ds_read_b128 v[196:199], v248 offset:39936
    v_mfma_f32_32x32x16_bf16 v[48:63], v[112:115], v[124:127], v[48:63]
    v_mfma_f32_32x32x16_bf16 v[64:79], v[116:119], v[124:127], v[64:79]
    v_mfma_f32_32x32x16_bf16 v[16:31], v[128:131], v[136:139], v[16:31]
    s_waitcnt lgkmcnt(0)
    s_barrier
    v_mfma_f32_32x32x16_bf16 v[32:47], v[132:135], v[136:139], v[32:47]
    v_mfma_f32_32x32x16_bf16 v[48:63], v[128:131], v[140:143], v[48:63]
    v_mfma_f32_32x32x16_bf16 v[64:79], v[132:135], v[140:143], v[64:79]
    v_mfma_f32_32x32x16_bf16 v[16:31], v[144:147], v[152:155], v[16:31]
    v_xor_b32 v248, 0x10000, v248
    v_xor_b32 v249, 0x10000, v249
    v_mfma_f32_32x32x16_bf16 v[32:47], v[148:151], v[152:155], v[32:47]
    v_xor_b32 v250, 0x10000, v250
    ds_read_b64_tr_b16 v[88:89], v249 offset:16384
    ds_read_b64_tr_b16 v[90:91], v249 offset:18432
    v_mfma_f32_32x32x16_bf16 v[48:63], v[144:147], v[156:159], v[48:63]
    ds_read_b64_tr_b16 v[92:93], v250 offset:16384
    ds_read_b64_tr_b16 v[94:95], v250 offset:18432
    ds_read_b128 v[80:83], v248 offset:0
    v_mfma_f32_32x32x16_bf16 v[64:79], v[148:151], v[156:159], v[64:79]
    ds_read_b128 v[84:87], v248 offset:4096
    ds_read_b64_tr_b16 v[104:105], v249 offset:20480
    v_mfma_f32_32x32x16_bf16 v[16:31], v[160:163], v[168:171], v[16:31]
    ds_read_b64_tr_b16 v[106:107], v249 offset:22528
    ds_read_b64_tr_b16 v[108:109], v250 offset:20480
    ds_read_b64_tr_b16 v[110:111], v250 offset:22528
    v_mfma_f32_32x32x16_bf16 v[32:47], v[164:167], v[168:171], v[32:47]
    ds_read_b128 v[96:99], v248 offset:1024
    ds_read_b128 v[100:103], v248 offset:5120
    ds_read_b64_tr_b16 v[120:121], v249 offset:24576
    v_mfma_f32_32x32x16_bf16 v[48:63], v[160:163], v[172:175], v[48:63]
    ds_read_b64_tr_b16 v[122:123], v249 offset:26624
    ds_read_b64_tr_b16 v[124:125], v250 offset:24576
    v_mfma_f32_32x32x16_bf16 v[64:79], v[164:167], v[172:175], v[64:79]
    ds_read_b64_tr_b16 v[126:127], v250 offset:26624
    ds_read_b128 v[112:115], v248 offset:2048
    ds_read_b128 v[116:119], v248 offset:6144
    v_mfma_f32_32x32x16_bf16 v[16:31], v[176:179], v[184:187], v[16:31]
    ds_read_b64_tr_b16 v[136:137], v249 offset:28672
    ds_read_b64_tr_b16 v[138:139], v249 offset:30720
    ds_read_b64_tr_b16 v[140:141], v250 offset:28672
    v_mfma_f32_32x32x16_bf16 v[32:47], v[180:183], v[184:187], v[32:47]
    ds_read_b64_tr_b16 v[142:143], v250 offset:30720
    ds_read_b128 v[128:131], v248 offset:3072
    ds_read_b128 v[132:135], v248 offset:7168
    v_mfma_f32_32x32x16_bf16 v[48:63], v[176:179], v[188:191], v[48:63]
    v_mfma_f32_32x32x16_bf16 v[64:79], v[180:183], v[188:191], v[64:79]
    v_mfma_f32_32x32x16_bf16 v[16:31], v[192:195], v[200:203], v[16:31]
    s_waitcnt lgkmcnt(0)
    s_barrier
    v_mfma_f32_32x32x16_bf16 v[32:47], v[196:199], v[200:203], v[32:47]
    v_mfma_f32_32x32x16_bf16 v[48:63], v[192:195], v[204:207], v[48:63]
    v_mfma_f32_32x32x16_bf16 v[64:79], v[196:199], v[204:207], v[64:79]
    v_mfma_f32_32x32x16_bf16 v[16:31], v[80:83], v[88:91], v[16:31]
    ds_read_b64_tr_b16 v[152:153], v249 offset:49152
    ds_read_b64_tr_b16 v[154:155], v249 offset:51200
    v_mfma_f32_32x32x16_bf16 v[32:47], v[84:87], v[88:91], v[32:47]
    ds_read_b64_tr_b16 v[156:157], v250 offset:49152
    ds_read_b64_tr_b16 v[158:159], v250 offset:51200
    v_mfma_f32_32x32x16_bf16 v[48:63], v[80:83], v[92:95], v[48:63]
    ds_read_b128 v[144:147], v248 offset:32768
    ds_read_b128 v[148:151], v248 offset:36864
    ds_read_b64_tr_b16 v[168:169], v249 offset:53248
    v_mfma_f32_32x32x16_bf16 v[64:79], v[84:87], v[92:95], v[64:79]
    ds_read_b64_tr_b16 v[170:171], v249 offset:55296
    ds_read_b64_tr_b16 v[172:173], v250 offset:53248
    v_mfma_f32_32x32x16_bf16 v[16:31], v[96:99], v[104:107], v[16:31]
    ds_read_b64_tr_b16 v[174:175], v250 offset:55296
    ds_read_b128 v[160:163], v248 offset:33792
    ds_read_b128 v[164:167], v248 offset:37888
    v_mfma_f32_32x32x16_bf16 v[32:47], v[100:103], v[104:107], v[32:47]
    ds_read_b64_tr_b16 v[184:185], v249 offset:57344
    ds_read_b64_tr_b16 v[186:187], v249 offset:59392
    v_mfma_f32_32x32x16_bf16 v[48:63], v[96:99], v[108:111], v[48:63]
    ds_read_b64_tr_b16 v[188:189], v250 offset:57344
    ds_read_b64_tr_b16 v[190:191], v250 offset:59392
    v_mfma_f32_32x32x16_bf16 v[64:79], v[100:103], v[108:111], v[64:79]
    ds_read_b128 v[176:179], v248 offset:34816
    ds_read_b128 v[180:183], v248 offset:38912
    ds_read_b64_tr_b16 v[200:201], v249 offset:61440
    v_mfma_f32_32x32x16_bf16 v[16:31], v[112:115], v[120:123], v[16:31]
    ds_read_b64_tr_b16 v[202:203], v249 offset:63488
    ds_read_b64_tr_b16 v[204:205], v250 offset:61440
    v_mfma_f32_32x32x16_bf16 v[32:47], v[116:119], v[120:123], v[32:47]
    ds_read_b64_tr_b16 v[206:207], v250 offset:63488
    ds_read_b128 v[192:195], v248 offset:35840
    ds_read_b128 v[196:199], v248 offset:39936
    v_mfma_f32_32x32x16_bf16 v[48:63], v[112:115], v[124:127], v[48:63]
    v_mfma_f32_32x32x16_bf16 v[64:79], v[116:119], v[124:127], v[64:79]
    v_mfma_f32_32x32x16_bf16 v[16:31], v[128:131], v[136:139], v[16:31]
    s_waitcnt lgkmcnt(0)
    s_barrier
    v_mfma_f32_32x32x16_bf16 v[32:47], v[132:135], v[136:139], v[32:47]
    v_mfma_f32_32x32x16_bf16 v[48:63], v[128:131], v[140:143], v[48:63]
    v_mfma_f32_32x32x16_bf16 v[64:79], v[132:135], v[140:143], v[64:79]
    v_mfma_f32_32x32x16_bf16 v[16:31], v[144:147], v[152:155], v[16:31]
    v_xor_b32 v248, 0x10000, v248
    v_xor_b32 v249, 0x10000, v249
    v_mfma_f32_32x32x16_bf16 v[32:47], v[148:151], v[152:155], v[32:47]
    v_xor_b32 v250, 0x10000, v250
    ds_read_b64_tr_b16 v[88:89], v249 offset:16384
    ds_read_b64_tr_b16 v[90:91], v249 offset:18432
    v_mfma_f32_32x32x16_bf16 v[48:63], v[144:147], v[156:159], v[48:63]
    ds_read_b64_tr_b16 v[92:93], v250 offset:16384
    ds_read_b64_tr_b16 v[94:95], v250 offset:18432
    ds_read_b128 v[80:83], v248 offset:0
    v_mfma_f32_32x32x16_bf16 v[64:79], v[148:151], v[156:159], v[64:79]
    ds_read_b128 v[84:87], v248 offset:4096
    ds_read_b64_tr_b16 v[104:105], v249 offset:20480
    v_mfma_f32_32x32x16_bf16 v[16:31], v[160:163], v[168:171], v[16:31]
    ds_read_b64_tr_b16 v[106:107], v249 offset:22528
    ds_read_b64_tr_b16 v[108:109], v250 offset:20480
    ds_read_b64_tr_b16 v[110:111], v250 offset:22528
    v_mfma_f32_32x32x16_bf16 v[32:47], v[164:167], v[168:171], v[32:47]
    ds_read_b128 v[96:99], v248 offset:1024
    ds_read_b128 v[100:103], v248 offset:5120
    ds_read_b64_tr_b16 v[120:121], v249 offset:24576
    v_mfma_f32_32x32x16_bf16 v[48:63], v[160:163], v[172:175], v[48:63]
    ds_read_b64_tr_b16 v[122:123], v249 offset:26624
    ds_read_b64_tr_b16 v[124:125], v250 offset:24576
    v_mfma_f32_32x32x16_bf16 v[64:79], v[164:167], v[172:175], v[64:79]
    ds_read_b64_tr_b16 v[126:127], v250 offset:26624
    ds_read_b128 v[112:115], v248 offset:2048
    ds_read_b128 v[116:119], v248 offset:6144
    v_mfma_f32_32x32x16_bf16 v[16:31], v[176:179], v[184:187], v[16:31]
    ds_read_b64_tr_b16 v[136:137], v249 offset:28672
    ds_read_b64_tr_b16 v[138:139], v249 offset:30720
    ds_read_b64_tr_b16 v[140:141], v250 offset:28672
    v_mfma_f32_32x32x16_bf16 v[32:47], v[180:183], v[184:187], v[32:47]
    ds_read_b64_tr_b16 v[142:143], v250 offset:30720
    ds_read_b128 v[128:131], v248 offset:3072
    ds_read_b128 v[132:135], v248 offset:7168
    v_mfma_f32_32x32x16_bf16 v[48:63], v[176:179], v[188:191], v[48:63]
    v_mfma_f32_32x32x16_bf16 v[64:79], v[180:183], v[188:191], v[64:79]
    v_mfma_f32_32x32x16_bf16 v[16:31], v[192:195], v[200:203], v[16:31]
    s_waitcnt lgkmcnt(0)
    s_barrier
    v_mfma_f32_32x32x16_bf16 v[32:47], v[196:199], v[200:203], v[32:47]
    v_mfma_f32_32x32x16_bf16 v[48:63], v[192:195], v[204:207], v[48:63]
    v_mfma_f32_32x32x16_bf16 v[64:79], v[196:199], v[204:207], v[64:79]
    v_mfma_f32_32x32x16_bf16 v[16:31], v[80:83], v[88:91], v[16:31]
    ds_read_b64_tr_b16 v[152:153], v249 offset:49152
    ds_read_b64_tr_b16 v[154:155], v249 offset:51200
    v_mfma_f32_32x32x16_bf16 v[32:47], v[84:87], v[88:91], v[32:47]
    ds_read_b64_tr_b16 v[156:157], v250 offset:49152
    ds_read_b64_tr_b16 v[158:159], v250 offset:51200
    v_mfma_f32_32x32x16_bf16 v[48:63], v[80:83], v[92:95], v[48:63]
    ds_read_b128 v[144:147], v248 offset:32768
    ds_read_b128 v[148:151], v248 offset:36864
    ds_read_b64_tr_b16 v[168:169], v249 offset:53248
    v_mfma_f32_32x32x16_bf16 v[64:79], v[84:87], v[92:95], v[64:79]
    ds_read_b64_tr_b16 v[170:171], v249 offset:55296
    ds_read_b64_tr_b16 v[172:173], v250 offset:53248
    v_mfma_f32_32x32x16_bf16 v[16:31], v[96:99], v[104:107], v[16:31]
    ds_read_b64_tr_b16 v[174:175], v250 offset:55296
    ds_read_b128 v[160:163], v248 offset:33792
    ds_read_b128 v[164:167], v248 offset:37888
    v_mfma_f32_32x32x16_bf16 v[32:47], v[100:103], v[104:107], v[32:47]
    ds_read_b64_tr_b16 v[184:185], v249 offset:57344
    ds_read_b64_tr_b16 v[186:187], v249 offset:59392
    v_mfma_f32_32x32x16_bf16 v[48:63], v[96:99], v[108:111], v[48:63]
    ds_read_b64_tr_b16 v[188:189], v250 offset:57344
    ds_read_b64_tr_b16 v[190:191], v250 offset:59392
    v_mfma_f32_32x32x16_bf16 v[64:79], v[100:103], v[108:111], v[64:79]
    ds_read_b128 v[176:179], v248 offset:34816
    ds_read_b128 v[180:183], v248 offset:38912
    ds_read_b64_tr_b16 v[200:201], v249 offset:61440
    v_mfma_f32_32x32x16_bf16 v[16:31], v[112:115], v[120:123], v[16:31]
    ds_read_b64_tr_b16 v[202:203], v249 offset:63488
    ds_read_b64_tr_b16 v[204:205], v250 offset:61440
    v_mfma_f32_32x32x16_bf16 v[32:47], v[116:119], v[120:123], v[32:47]
    ds_read_b64_tr_b16 v[206:207], v250 offset:63488
    ds_read_b128 v[192:195], v248 offset:35840
    ds_read_b128 v[196:199], v248 offset:39936
    v_mfma_f32_32x32x16_bf16 v[48:63], v[112:115], v[124:127], v[48:63]
    v_mfma_f32_32x32x16_bf16 v[64:79], v[116:119], v[124:127], v[64:79]
    v_mfma_f32_32x32x16_bf16 v[16:31], v[128:131], v[136:139], v[16:31]
    s_waitcnt lgkmcnt(0)
    s_barrier
    v_mfma_f32_32x32x16_bf16 v[32:47], v[132:135], v[136:139], v[32:47]
    v_mfma_f32_32x32x16_bf16 v[48:63], v[128:131], v[140:143], v[48:63]
    v_mfma_f32_32x32x16_bf16 v[64:79], v[132:135], v[140:143], v[64:79]
    v_mfma_f32_32x32x16_bf16 v[16:31], v[144:147], v[152:155], v[16:31]
    v_xor_b32 v248, 0x10000, v248
    v_xor_b32 v249, 0x10000, v249
    v_mfma_f32_32x32x16_bf16 v[32:47], v[148:151], v[152:155], v[32:47]
    v_xor_b32 v250, 0x10000, v250
    ds_read_b64_tr_b16 v[88:89], v249 offset:16384
    ds_read_b64_tr_b16 v[90:91], v249 offset:18432
    v_mfma_f32_32x32x16_bf16 v[48:63], v[144:147], v[156:159], v[48:63]
    ds_read_b64_tr_b16 v[92:93], v250 offset:16384
    ds_read_b64_tr_b16 v[94:95], v250 offset:18432
    ds_read_b128 v[80:83], v248 offset:0
    v_mfma_f32_32x32x16_bf16 v[64:79], v[148:151], v[156:159], v[64:79]
    ds_read_b128 v[84:87], v248 offset:4096
    ds_read_b64_tr_b16 v[104:105], v249 offset:20480
    v_mfma_f32_32x32x16_bf16 v[16:31], v[160:163], v[168:171], v[16:31]
    ds_read_b64_tr_b16 v[106:107], v249 offset:22528
    ds_read_b64_tr_b16 v[108:109], v250 offset:20480
    ds_read_b64_tr_b16 v[110:111], v250 offset:22528
    v_mfma_f32_32x32x16_bf16 v[32:47], v[164:167], v[168:171], v[32:47]
    ds_read_b128 v[96:99], v248 offset:1024
    ds_read_b128 v[100:103], v248 offset:5120
    ds_read_b64_tr_b16 v[120:121], v249 offset:24576
    v_mfma_f32_32x32x16_bf16 v[48:63], v[160:163], v[172:175], v[48:63]
    ds_read_b64_tr_b16 v[122:123], v249 offset:26624
    ds_read_b64_tr_b16 v[124:125], v250 offset:24576
    v_mfma_f32_32x32x16_bf16 v[64:79], v[164:167], v[172:175], v[64:79]
    ds_read_b64_tr_b16 v[126:127], v250 offset:26624
    ds_read_b128 v[112:115], v248 offset:2048
    ds_read_b128 v[116:119], v248 offset:6144
    v_mfma_f32_32x32x16_bf16 v[16:31], v[176:179], v[184:187], v[16:31]
    ds_read_b64_tr_b16 v[136:137], v249 offset:28672
    ds_read_b64_tr_b16 v[138:139], v249 offset:30720
    ds_read_b64_tr_b16 v[140:141], v250 offset:28672
    v_mfma_f32_32x32x16_bf16 v[32:47], v[180:183], v[184:187], v[32:47]
    ds_read_b64_tr_b16 v[142:143], v250 offset:30720
    ds_read_b128 v[128:131], v248 offset:3072
    ds_read_b128 v[132:135], v248 offset:7168
    v_mfma_f32_32x32x16_bf16 v[48:63], v[176:179], v[188:191], v[48:63]
    v_mfma_f32_32x32x16_bf16 v[64:79], v[180:183], v[188:191], v[64:79]
    v_mfma_f32_32x32x16_bf16 v[16:31], v[192:195], v[200:203], v[16:31]
    s_waitcnt lgkmcnt(0)
    s_barrier
    v_mfma_f32_32x32x16_bf16 v[32:47], v[196:199], v[200:203], v[32:47]
    v_mfma_f32_32x32x16_bf16 v[48:63], v[192:195], v[204:207], v[48:63]
    v_mfma_f32_32x32x16_bf16 v[64:79], v[196:199], v[204:207], v[64:79]
    v_mfma_f32_32x32x16_bf16 v[16:31], v[80:83], v[88:91], v[16:31]
    ds_read_b64_tr_b16 v[152:153], v249 offset:49152
    v_mfma_f32_32x32x16_bf16 v[32:47], v[84:87], v[88:91], v[32:47]
    ds_read_b64_tr_b16 v[154:155], v249 offset:51200
    v_mfma_f32_32x32x16_bf16 v[48:63], v[80:83], v[92:95], v[48:63]
    ds_read_b64_tr_b16 v[156:157], v250 offset:49152
    v_mfma_f32_32x32x16_bf16 v[64:79], v[84:87], v[92:95], v[64:79]
    ds_read_b64_tr_b16 v[158:159], v250 offset:51200
    v_mfma_f32_32x32x16_bf16 v[16:31], v[96:99], v[104:107], v[16:31]
    ds_read_b128 v[144:147], v248 offset:32768
    ds_read_b128 v[148:151], v248 offset:36864
    v_mfma_f32_32x32x16_bf16 v[32:47], v[100:103], v[104:107], v[32:47]
    ds_read_b64_tr_b16 v[168:169], v249 offset:53248
    v_mfma_f32_32x32x16_bf16 v[48:63], v[96:99], v[108:111], v[48:63]
    ds_read_b64_tr_b16 v[170:171], v249 offset:55296
    v_mfma_f32_32x32x16_bf16 v[64:79], v[100:103], v[108:111], v[64:79]
    ds_read_b64_tr_b16 v[172:173], v250 offset:53248
    v_mfma_f32_32x32x16_bf16 v[16:31], v[112:115], v[120:123], v[16:31]
    ds_read_b64_tr_b16 v[174:175], v250 offset:55296
    v_mfma_f32_32x32x16_bf16 v[32:47], v[116:119], v[120:123], v[32:47]
    ds_read_b128 v[160:163], v248 offset:33792
    ds_read_b128 v[164:167], v248 offset:37888
    v_mfma_f32_32x32x16_bf16 v[48:63], v[112:115], v[124:127], v[48:63]
    v_mfma_f32_32x32x16_bf16 v[64:79], v[116:119], v[124:127], v[64:79]
    v_mfma_f32_32x32x16_bf16 v[16:31], v[128:131], v[136:139], v[16:31]
    s_waitcnt lgkmcnt(0)
    v_mfma_f32_32x32x16_bf16 v[32:47], v[132:135], v[136:139], v[32:47]
    v_mfma_f32_32x32x16_bf16 v[48:63], v[128:131], v[140:143], v[48:63]
    v_mfma_f32_32x32x16_bf16 v[64:79], v[132:135], v[140:143], v[64:79]
    v_mfma_f32_32x32x16_bf16 v[16:31], v[144:147], v[152:155], v[16:31]
    v_mfma_f32_32x32x16_bf16 v[16:31], v[160:163], v[168:171], v[16:31]
    v_mfma_f32_32x32x16_bf16 v[32:47], v[148:151], v[152:155], v[32:47]
    v_mfma_f32_32x32x16_bf16 v[32:47], v[164:167], v[168:171], v[32:47]
    v_mfma_f32_32x32x16_bf16 v[48:63], v[144:147], v[156:159], v[48:63]
    v_mfma_f32_32x32x16_bf16 v[48:63], v[160:163], v[172:175], v[48:63]
    s_nop 7
    v_cvt_pk_bf16_f32 v80, v16, v17
    v_cvt_pk_bf16_f32 v81, v18, v19
    buffer_store_dwordx2 v[80:81], v251, s[20:23], s36 offen offset:0 sc1
    v_cvt_pk_bf16_f32 v82, v20, v21
    v_cvt_pk_bf16_f32 v83, v22, v23
    buffer_store_dwordx2 v[82:83], v251, s[20:23], s36 offen offset:1024 sc1
    v_cvt_pk_bf16_f32 v84, v24, v25
    v_cvt_pk_bf16_f32 v85, v26, v27
    buffer_store_dwordx2 v[84:85], v251, s[20:23], s36 offen offset:2048 sc1
    v_cvt_pk_bf16_f32 v86, v28, v29
    v_cvt_pk_bf16_f32 v87, v30, v31
    buffer_store_dwordx2 v[86:87], v251, s[20:23], s36 offen offset:3072 sc1
    v_mfma_f32_32x32x16_bf16 v[64:79], v[148:151], v[156:159], v[64:79]
    v_mfma_f32_32x32x16_bf16 v[64:79], v[164:167], v[172:175], v[64:79]
    v_cvt_pk_bf16_f32 v88, v32, v33
    v_cvt_pk_bf16_f32 v89, v34, v35
    buffer_store_dwordx2 v[88:89], v251, s[20:23], s37 offen offset:0 sc1
    v_cvt_pk_bf16_f32 v90, v36, v37
    v_cvt_pk_bf16_f32 v91, v38, v39
    buffer_store_dwordx2 v[90:91], v251, s[20:23], s37 offen offset:1024 sc1
    v_cvt_pk_bf16_f32 v92, v40, v41
    v_cvt_pk_bf16_f32 v93, v42, v43
    buffer_store_dwordx2 v[92:93], v251, s[20:23], s37 offen offset:2048 sc1
    v_cvt_pk_bf16_f32 v94, v44, v45
    v_cvt_pk_bf16_f32 v95, v46, v47
    buffer_store_dwordx2 v[94:95], v251, s[20:23], s37 offen offset:3072 sc1
    v_cvt_pk_bf16_f32 v96, v48, v49
    v_cvt_pk_bf16_f32 v97, v50, v51
    buffer_store_dwordx2 v[96:97], v251, s[20:23], s36 offen offset:256 sc1
    v_cvt_pk_bf16_f32 v98, v52, v53
    v_cvt_pk_bf16_f32 v99, v54, v55
    buffer_store_dwordx2 v[98:99], v251, s[20:23], s36 offen offset:1280 sc1
    v_cvt_pk_bf16_f32 v100, v56, v57
    v_cvt_pk_bf16_f32 v101, v58, v59
    buffer_store_dwordx2 v[100:101], v251, s[20:23], s36 offen offset:2304 sc1
    v_cvt_pk_bf16_f32 v102, v60, v61
    v_cvt_pk_bf16_f32 v103, v62, v63
    buffer_store_dwordx2 v[102:103], v251, s[20:23], s36 offen offset:3328 sc1
    v_cvt_pk_bf16_f32 v104, v64, v65
    v_cvt_pk_bf16_f32 v105, v66, v67
    buffer_store_dwordx2 v[104:105], v251, s[20:23], s37 offen offset:256 sc1
    v_cvt_pk_bf16_f32 v106, v68, v69
    v_cvt_pk_bf16_f32 v107, v70, v71
    buffer_store_dwordx2 v[106:107], v251, s[20:23], s37 offen offset:1280 sc1
    v_cvt_pk_bf16_f32 v108, v72, v73
    v_cvt_pk_bf16_f32 v109, v74, v75
    buffer_store_dwordx2 v[108:109], v251, s[20:23], s37 offen offset:2304 sc1
    v_cvt_pk_bf16_f32 v110, v76, v77
    v_cvt_pk_bf16_f32 v111, v78, v79
    buffer_store_dwordx2 v[110:111], v251, s[20:23], s37 offen offset:3328 sc1
    s_branch Lp3
Lp1:
    s_sub_u32 s29, s32, 28
    s_lshl_b32 s29, s29, 3
    s_add_u32 s29, s29, s31
    s_lshl_b32 s29, s29, 1
    s_lshr_b32 s46, s28, 2
    s_add_u32 s47, s46, s29
    s_and_b32 s48, s28, 3
    s_lshl_b32 s34, s48, 9
    s_add_u32 s47, s47, s34
    s_mul_i32 s33, s47, 1280
    s_mul_i32 s34, s28, 10240
    s_mov_b32 s35, 81920
    v_and_b32 v1, 15, v0
    v_lshrrev_b32 v2, 4, v0
    v_lshlrev_b32 v4, 2, v2
    v_xor_b32 v3, v1, v4
    v_mul_u32_u24 v4, s35, v2
    v_lshl_add_u32 v4, v3, 4, v4
    s_waitcnt lgkmcnt(0)
    s_mov_b32 s12, s4
    s_mov_b32 s13, s5
    s_mov_b32 s14, 2621440
    s_mov_b32 s15, 0x00020000
    s_add_u32 s36, s6, 0x700000
    s_addc_u32 s37, s7, 0
    s_mov_b32 s38, 2883584
    s_mov_b32 s39, 0x00020000
    s_add_u32 m0, s34, 0
    s_add_u32 s40, s33, 0
    buffer_load_dwordx4 v4, s[12:15], s40 offen lds
    s_add_u32 m0, s34, 1024
    s_add_u32 s40, s33, 256
    buffer_load_dwordx4 v4, s[12:15], s40 offen lds
    s_add_u32 m0, s34, 2048
    s_add_u32 s40, s33, 512
    buffer_load_dwordx4 v4, s[12:15], s40 offen lds
    s_add_u32 m0, s34, 3072
    s_add_u32 s40, s33, 768
    buffer_load_dwordx4 v4, s[12:15], s40 offen lds
    s_add_u32 m0, s34, 4096
    s_add_u32 s40, s33, 1024
    buffer_load_dwordx4 v4, s[12:15], s40 offen lds
    s_add_u32 m0, s34, 5120
    s_add_u32 s40, s33, 327680
    buffer_load_dwordx4 v4, s[12:15], s40 offen lds
    s_add_u32 m0, s34, 6144
    s_add_u32 s40, s33, 327936
    buffer_load_dwordx4 v4, s[12:15], s40 offen lds
    s_add_u32 m0, s34, 7168
    s_add_u32 s40, s33, 328192
    buffer_load_dwordx4 v4, s[12:15], s40 offen lds
    s_add_u32 m0, s34, 8192
    s_add_u32 s40, s33, 328448
    buffer_load_dwordx4 v4, s[12:15], s40 offen lds
    s_add_u32 m0, s34, 9216
    s_add_u32 s40, s33, 328704
    buffer_load_dwordx4 v4, s[12:15], s40 offen lds
    s_add_u32 s52, s6, 0x1200000
    s_addc_u32 s53, s7, 0
    s_mov_b32 s54, 155648
    s_mov_b32 s55, 0x00020000
    s_mov_b32 s56, s50
    s_mov_b32 s57, s51
    s_mov_b32 s58, 256
    s_mov_b32 s59, 0x00020000
    s_load_dwordx4 s[24:27], s[0:1], 8
    s_sub_u32 s20, s32, 20
    s_mul_i32 s21, s20, 43
    s_lshr_b32 s21, s21, 7
    s_mul_i32 s22, s21, 3
    s_sub_u32 s22, s20, s22
    s_lshl_b32 s20, s31, 2
    s_add_u32 s20, s20, s21
    s_lshl_b32 s23, s22, 7
    s_cmp_eq_u32 s22, 2
    s_cselect_b32 s23, 226, s23
    v_lshrrev_b32 v8, 3, v0
    v_lshl_add_u32 v8, v8, 5, s20
    v_mul_u32_u24 v8, 642, v8
    v_and_b32 v9, 7, v0
    v_lshl_add_u32 v8, v9, 4, v8
    s_bfe_u32 s21, s28, 0x10001
    s_mulk_i32 s21, 320
    s_add_u32 s23, s23, s21
    s_and_b32 s21, s28, 1
    s_mul_i32 s21, s21, 657408
    s_add_u32 s23, s23, s21
    v_add_u32 v8, s23, v8
    s_lshl_b32 s21, s28, 12
    s_waitcnt lgkmcnt(0)
    s_cmp_lt_u32 s28, 4
    s_cselect_b32 s16, s24, s26
    s_cselect_b32 s17, s25, s27
    s_mov_b32 s18, 1314816
    s_mov_b32 s19, 0x00020000
    v_mov_b32 v146, v8
    s_mov_b32 s23, 1
    s_and_b32 s41, s28, 1
    s_add_u32 s41, s41, 4
    s_bfe_u32 s42, s28, 0x10001
    s_cmp_lt_u32 s28, 4
    s_cselect_b32 s43, s28, s41
    s_cselect_b32 s44, 0, s42
    s_cselect_b32 s45, 1, 0
    v_lshl_add_u32 v8, v2, 6, s47
    v_cvt_f32_u32 v8, v8
    v_mul_f32 v8, 0x3a000000, v8
    v_cvt_f32_u32 v9, v1
    v_add_f32 v10, 0x41800000, v9
    v_mul_f32 v12, v8, v9
    v_cos_f32 v208, v12
    v_sin_f32 v212, v12
    v_mul_f32 v12, v8, v10
    v_cos_f32 v210, v12
    v_sin_f32 v214, v12
    v_add_f32 v8, 0x3e000000, v8
    v_mul_f32 v12, v8, v9
    v_cos_f32 v209, v12
    v_sin_f32 v213, v12
    v_mul_f32 v12, v8, v10
    v_cos_f32 v211, v12
    v_sin_f32 v215, v12
    v_lshrrev_b32 v8, 5, v0
    v_mul_u32_u24 v9, 5120, v8
    v_add_u32 v9, s34, v9
    v_bfe_u32 v8, v0, 3, 2
    v_lshl_add_u32 v9, v8, 8, v9
    v_lshl_add_u32 v224, v1, 4, v9
    v_xor_b32 v225, 128, v224
    v_mov_b32 v228, 0
    v_mov_b32 v229, 0
    v_mov_b32 v230, 0
    v_mov_b32 v231, 0
    s_mov_b32 s49, 0x3f803f80
    s_mul_i32 s41, s46, 6144
    s_lshl_b32 s42, s48, 2
    s_add_u32 s41, s41, s42
    s_add_u32 s41, s41, 81920
    v_lshl_add_u32 v226, v0, 4, s41
    s_lshl_b32 s41, s46, 6
    s_add_u32 s41, s41, s42
    s_add_u32 s41, s41, 94208
    v_lshl_add_u32 v227, v2, 4, s41
    s_lshl_b32 s41, s43, 4
    v_add_u32 v3, s41, v1
    v_cvt_f32_u32 v4, v3
    v_mul_f32 v5, 0x3bcccccd, v4
    v_cvt_f32_u32 v6, v2
    v_mul_f32 v6, 4.0, v6
    v_mul_f32 v6, v6, v5
    v_and_b32 v14, 1, v0
    v_mov_b32 v15, 0x80008000
    v_mul_lo_u32 v14, v14, v15
    v_fmamk_f32 v8, v5, 0x00000000, v6
    v_fmamk_f32 v9, v5, 0x3f800000, v6
    v_cos_f32 v10, v8
    v_cos_f32 v11, v9
    v_sin_f32 v12, v8
    v_sin_f32 v13, v9
    v_cvt_pk_bf16_f32 v16, v10, v11
    v_cvt_pk_bf16_f32 v20, -v12, -v13
    v_xor_b32 v18, v14, v16
    v_xor_b32 v22, v14, v20
    v_fmamk_f32 v8, v5, 0x40000000, v6
    v_fmamk_f32 v9, v5, 0x40400000, v6
    v_cos_f32 v10, v8
    v_cos_f32 v11, v9
    v_sin_f32 v12, v8
    v_sin_f32 v13, v9
    v_cvt_pk_bf16_f32 v17, v10, v11
    v_cvt_pk_bf16_f32 v21, -v12, -v13
    v_xor_b32 v19, v14, v17
    v_xor_b32 v23, v14, v21
    v_fmamk_f32 v8, v5, 0x41800000, v6
    v_fmamk_f32 v9, v5, 0x41880000, v6
    v_cos_f32 v10, v8
    v_cos_f32 v11, v9
    v_sin_f32 v12, v8
    v_sin_f32 v13, v9
    v_cvt_pk_bf16_f32 v24, v10, v11
    v_cvt_pk_bf16_f32 v28, -v12, -v13
    v_xor_b32 v26, v14, v24
    v_xor_b32 v30, v14, v28
    v_fmamk_f32 v8, v5, 0x41900000, v6
    v_fmamk_f32 v9, v5, 0x41980000, v6
    v_cos_f32 v10, v8
    v_cos_f32 v11, v9
    v_sin_f32 v12, v8
    v_sin_f32 v13, v9
    v_cvt_pk_bf16_f32 v25, v10, v11
    v_cvt_pk_bf16_f32 v29, -v12, -v13
    v_xor_b32 v27, v14, v25
    v_xor_b32 v31, v14, v29
    v_fmamk_f32 v8, v5, 0x42000000, v6
    v_fmamk_f32 v9, v5, 0x42040000, v6
    v_cos_f32 v10, v8
    v_cos_f32 v11, v9
    v_sin_f32 v12, v8
    v_sin_f32 v13, v9
    v_cvt_pk_bf16_f32 v32, v10, v11
    v_cvt_pk_bf16_f32 v36, -v12, -v13
    v_xor_b32 v34, v14, v32
    v_xor_b32 v38, v14, v36
    v_fmamk_f32 v8, v5, 0x42080000, v6
    v_fmamk_f32 v9, v5, 0x420c0000, v6
    v_cos_f32 v10, v8
    v_cos_f32 v11, v9
    v_sin_f32 v12, v8
    v_sin_f32 v13, v9
    v_cvt_pk_bf16_f32 v33, v10, v11
    v_cvt_pk_bf16_f32 v37, -v12, -v13
    v_xor_b32 v35, v14, v33
    v_xor_b32 v39, v14, v37
    v_fmamk_f32 v8, v5, 0x42400000, v6
    v_fmamk_f32 v9, v5, 0x42440000, v6
    v_cos_f32 v10, v8
    v_cos_f32 v11, v9
    v_sin_f32 v12, v8
    v_sin_f32 v13, v9
    v_cvt_pk_bf16_f32 v40, v10, v11
    v_cvt_pk_bf16_f32 v44, -v12, -v13
    v_xor_b32 v42, v14, v40
    v_xor_b32 v46, v14, v44
    v_fmamk_f32 v8, v5, 0x42480000, v6
    v_fmamk_f32 v9, v5, 0x424c0000, v6
    v_cos_f32 v10, v8
    v_cos_f32 v11, v9
    v_sin_f32 v12, v8
    v_sin_f32 v13, v9
    v_cvt_pk_bf16_f32 v41, v10, v11
    v_cvt_pk_bf16_f32 v45, -v12, -v13
    v_xor_b32 v43, v14, v41
    v_xor_b32 v47, v14, v45
    v_fmamk_f32 v8, v5, 0x42800000, v6
    v_fmamk_f32 v9, v5, 0x42820000, v6
    v_cos_f32 v10, v8
    v_cos_f32 v11, v9
    v_sin_f32 v12, v8
    v_sin_f32 v13, v9
    v_cvt_pk_bf16_f32 v48, v10, v11
    v_cvt_pk_bf16_f32 v52, -v12, -v13
    v_xor_b32 v50, v14, v48
    v_xor_b32 v54, v14, v52
    v_fmamk_f32 v8, v5, 0x42840000, v6
    v_fmamk_f32 v9, v5, 0x42860000, v6
    v_cos_f32 v10, v8
    v_cos_f32 v11, v9
    v_sin_f32 v12, v8
    v_sin_f32 v13, v9
    v_cvt_pk_bf16_f32 v49, v10, v11
    v_cvt_pk_bf16_f32 v53, -v12, -v13
    v_xor_b32 v51, v14, v49
    v_xor_b32 v55, v14, v53
    v_mul_f32 v8, 0x3acccccd, v4
    v_cos_f32 v56, v8
    v_sin_f32 v57, v8
    v_mul_f32 v8, 0x3b4ccccd, v4
    v_cos_f32 v58, v8
    v_sin_f32 v59, v8
    v_mul_f32 v8, 0x3b99999a, v4
    v_cos_f32 v60, v8
    v_sin_f32 v61, v8
    v_and_b32 v8, 3, v0
    v_bfe_u32 v9, v0, 3, 1
    v_lshl_add_u32 v9, v2, 1, v9
    v_lshlrev_b32 v10, 2, v8
    v_xor_b32 v9, v9, v10
    v_lshlrev_b32 v10, 8, v8
    v_lshl_add_u32 v10, v9, 4, v10
    v_bfe_u32 v9, v0, 2, 1
    v_lshl_add_u32 v14, v9, 3, v10
    s_mul_i32 s41, s44, 40960
    v_add_u32 v14, s41, v14
    v_xor_b32 v15, 128, v14
    s_mul_i32 s41, s44, 6144
    s_add_u32 s41, s41, 81920
    v_lshl_add_u32 v7, v0, 4, s41
    s_lshl_b32 s41, s44, 6
    s_add_u32 s41, s41, 94208
    v_lshl_add_u32 v62, v2, 4, s41
    v_lshrrev_b32 v8, 3, v0
    s_mov_b32 s41, 90112
    v_mul_lo_u32 v63, v8, s41
    v_and_b32 v9, 7, v0
    v_lshl_add_u32 v63, v9, 4, v63
    s_lshl_b32 s41, s28, 12
    s_add_u32 s41, s41, 98304
    v_xor_b32 v10, v8, v9
    v_lshl_add_u32 v3, v8, 7, s41
    v_lshl_add_u32 v3, v10, 4, v3
    v_xor_b32 v10, v2, v9
    v_lshl_add_u32 v5, v1, 7, s41
    v_lshl_add_u32 v5, v10, 4, v5
    v_xor_b32 v6, 64, v5
    s_waitcnt vmcnt(0)
    ds_read_b128 v[64:67], v224 offset:0
    ds_read_b128 v[68:71], v225 offset:0
    ds_read_b128 v[72:75], v224 offset:1024
    ds_read_b128 v[76:79], v225 offset:1024
    ds_read_b128 v[80:83], v224 offset:2048
    ds_read_b128 v[84:87], v225 offset:2048
    ds_read_b128 v[88:91], v224 offset:3072
    ds_read_b128 v[92:95], v225 offset:3072
    ds_read_b128 v[96:99], v224 offset:4096
    ds_read_b128 v[100:103], v225 offset:4096
    s_waitcnt lgkmcnt(8)
    v_dot2c_f32_bf16 v228, s49, v64
    v_dot2c_f32_bf16 v230, v64, v64
    v_dot2c_f32_bf16 v229, s49, v65
    v_dot2c_f32_bf16 v231, v65, v65
    v_dot2c_f32_bf16 v228, s49, v66
    v_dot2c_f32_bf16 v230, v66, v66
    v_dot2c_f32_bf16 v229, s49, v67
    v_dot2c_f32_bf16 v231, v67, v67
    v_dot2c_f32_bf16 v228, s49, v68
    v_dot2c_f32_bf16 v230, v68, v68
    v_dot2c_f32_bf16 v229, s49, v69
    v_dot2c_f32_bf16 v231, v69, v69
    v_dot2c_f32_bf16 v228, s49, v70
    v_dot2c_f32_bf16 v230, v70, v70
    v_dot2c_f32_bf16 v229, s49, v71
    v_dot2c_f32_bf16 v231, v71, v71
    s_waitcnt lgkmcnt(6)
    v_dot2c_f32_bf16 v228, s49, v72
    v_dot2c_f32_bf16 v230, v72, v72
    v_dot2c_f32_bf16 v229, s49, v73
    v_dot2c_f32_bf16 v231, v73, v73
    v_dot2c_f32_bf16 v228, s49, v74
    v_dot2c_f32_bf16 v230, v74, v74
    v_dot2c_f32_bf16 v229, s49, v75
    v_dot2c_f32_bf16 v231, v75, v75
    v_dot2c_f32_bf16 v228, s49, v76
    v_dot2c_f32_bf16 v230, v76, v76
    v_dot2c_f32_bf16 v229, s49, v77
    v_dot2c_f32_bf16 v231, v77, v77
    v_dot2c_f32_bf16 v228, s49, v78
    v_dot2c_f32_bf16 v230, v78, v78
    v_dot2c_f32_bf16 v229, s49, v79
    v_dot2c_f32_bf16 v231, v79, v79
    s_waitcnt lgkmcnt(4)
    v_dot2c_f32_bf16 v228, s49, v80
    v_dot2c_f32_bf16 v230, v80, v80
    v_dot2c_f32_bf16 v229, s49, v81
    v_dot2c_f32_bf16 v231, v81, v81
    v_dot2c_f32_bf16 v228, s49, v82
    v_dot2c_f32_bf16 v230, v82, v82
    v_dot2c_f32_bf16 v229, s49, v83
    v_dot2c_f32_bf16 v231, v83, v83
    v_dot2c_f32_bf16 v228, s49, v84
    v_dot2c_f32_bf16 v230, v84, v84
    v_dot2c_f32_bf16 v229, s49, v85
    v_dot2c_f32_bf16 v231, v85, v85
    v_dot2c_f32_bf16 v228, s49, v86
    v_dot2c_f32_bf16 v230, v86, v86
    v_dot2c_f32_bf16 v229, s49, v87
    v_dot2c_f32_bf16 v231, v87, v87
    s_waitcnt lgkmcnt(2)
    v_dot2c_f32_bf16 v228, s49, v88
    v_dot2c_f32_bf16 v230, v88, v88
    v_dot2c_f32_bf16 v229, s49, v89
    v_dot2c_f32_bf16 v231, v89, v89
    v_dot2c_f32_bf16 v228, s49, v90
    v_dot2c_f32_bf16 v230, v90, v90
    v_dot2c_f32_bf16 v229, s49, v91
    v_dot2c_f32_bf16 v231, v91, v91
    v_dot2c_f32_bf16 v228, s49, v92
    v_dot2c_f32_bf16 v230, v92, v92
    v_dot2c_f32_bf16 v229, s49, v93
    v_dot2c_f32_bf16 v231, v93, v93
    v_dot2c_f32_bf16 v228, s49, v94
    v_dot2c_f32_bf16 v230, v94, v94
    v_dot2c_f32_bf16 v229, s49, v95
    v_dot2c_f32_bf16 v231, v95, v95
    s_waitcnt lgkmcnt(0)
    v_dot2c_f32_bf16 v228, s49, v96
    v_dot2c_f32_bf16 v230, v96, v96
    v_dot2c_f32_bf16 v229, s49, v97
    v_dot2c_f32_bf16 v231, v97, v97
    v_dot2c_f32_bf16 v228, s49, v98
    v_dot2c_f32_bf16 v230, v98, v98
    v_dot2c_f32_bf16 v229, s49, v99
    v_dot2c_f32_bf16 v231, v99, v99
    v_dot2c_f32_bf16 v228, s49, v100
    v_dot2c_f32_bf16 v230, v100, v100
    v_dot2c_f32_bf16 v229, s49, v101
    v_dot2c_f32_bf16 v231, v101, v101
    v_dot2c_f32_bf16 v228, s49, v102
    v_dot2c_f32_bf16 v230, v102, v102
    v_dot2c_f32_bf16 v229, s49, v103
    v_dot2c_f32_bf16 v231, v103, v103
    s_nop 1
    v_add_f32 v228, v228, v229
    v_add_f32 v230, v230, v231
    s_nop 0
    v_add_f32_dpp v228, v228, v228 quad_perm:[1,0,3,2] row_mask:0xf bank_mask:0xf
    v_add_f32_dpp v230, v230, v230 quad_perm:[1,0,3,2] row_mask:0xf bank_mask:0xf
    s_nop 0
    v_add_f32_dpp v228, v228, v228 quad_perm:[2,3,0,1] row_mask:0xf bank_mask:0xf
    v_add_f32_dpp v230, v230, v230 quad_perm:[2,3,0,1] row_mask:0xf bank_mask:0xf
    s_nop 0
    v_add_f32_dpp v228, v228, v228 row_half_mirror row_mask:0xf bank_mask:0xf
    v_add_f32_dpp v230, v230, v230 row_half_mirror row_mask:0xf bank_mask:0xf
    v_mul_f32 v10, 0x3acccccd, v228
    v_mul_f32 v8, 0x3acccccd, v230
    v_fma_f32 v8, -v10, v10, v8
    v_max_f32 v8, 0, v8
    v_cvt_pk_bf16_f32 v8, v8, v8
    v_lshlrev_b32 v8, 16, v8
    v_add_f32 v8, 0x3727c5ac, v8
    v_cvt_pk_bf16_f32 v8, v8, v8
    v_lshlrev_b32 v8, 16, v8
    v_sqrt_f32 v11, v8
    s_nop 0
    v_cvt_pk_bf16_f32 v11, v11, v10
    v_lshlrev_b32 v8, 5, v2
    v_and_b32 v10, 0xffff0000, v11
    v_lshlrev_b32 v11, 16, v11
    v_rcp_f32 v11, v11
    v_fmac_f32 v228, 0xc4200000, v10
    ds_bpermute_b32 v232, v8, v11 offset:0
    ds_bpermute_b32 v234, v8, v228 offset:0
    ds_bpermute_b32 v233, v8, v11 offset:128
    ds_bpermute_b32 v235, v8, v228 offset:128
    s_waitcnt lgkmcnt(0)
    v_mul_f32 v208, v208, v232
    v_mul_f32 v212, v212, v232
    v_mul_f32 v209, v209, v233
    v_mul_f32 v213, v213, v233
    v_cvt_pk_bf16_f32 v236, v208, v209
    v_cvt_pk_bf16_f32 v237, v212, v213
    v_cvt_pk_bf16_f32 v238, -v212, -v213
    ds_write_b32 v226, v236 offset:0
    ds_write_b32 v226, v237 offset:1024
    ds_write_b32 v226, v238 offset:2048
    v_mul_f32 v210, v210, v232
    v_mul_f32 v214, v214, v232
    v_mul_f32 v211, v211, v233
    v_mul_f32 v215, v215, v233
    v_cvt_pk_bf16_f32 v239, v210, v211
    v_cvt_pk_bf16_f32 v240, v214, v215
    v_cvt_pk_bf16_f32 v241, -v214, -v215
    ds_write_b32 v226, v239 offset:3072
    ds_write_b32 v226, v240 offset:4096
    ds_write_b32 v226, v241 offset:5120
    v_cvt_pk_bf16_f32 v8, v234, v235
    ds_write_b32 v227, v8
    s_waitcnt lgkmcnt(0)
    s_barrier
Lp1_unit:
    ds_read_b64_tr_b16 v[64:65], v14 offset:0
    ds_read_b64_tr_b16 v[66:67], v15 offset:2048
    ds_read_b64_tr_b16 v[68:69], v15 offset:0
    ds_read_b64_tr_b16 v[70:71], v14 offset:3072
    ds_read_b64_tr_b16 v[72:73], v14 offset:1024
    ds_read_b64_tr_b16 v[74:75], v15 offset:3072
    ds_read_b64_tr_b16 v[76:77], v15 offset:1024
    ds_read_b64_tr_b16 v[78:79], v14 offset:4096
    ds_read_b64_tr_b16 v[80:81], v14 offset:2048
    ds_read_b64_tr_b16 v[82:83], v15 offset:4096
    s_waitcnt lgkmcnt(0)
    v_mfma_f32_16x16x32_bf16 v[104:107], v[64:67], v[16:19], 0
    ds_read_b64_tr_b16 v[84:85], v14 offset:5120
    v_mfma_f32_16x16x32_bf16 v[108:111], v[64:67], v[20:23], 0
    ds_read_b64_tr_b16 v[86:87], v15 offset:7168
    v_mfma_f32_16x16x32_bf16 v[104:107], v[68:71], v[24:27], v[104:107]
    ds_read_b64_tr_b16 v[88:89], v15 offset:5120
    v_mfma_f32_16x16x32_bf16 v[108:111], v[68:71], v[28:31], v[108:111]
    ds_read_b64_tr_b16 v[90:91], v14 offset:8192
    v_mfma_f32_16x16x32_bf16 v[104:107], v[72:75], v[32:35], v[104:107]
    ds_read_b64_tr_b16 v[92:93], v14 offset:6144
    v_mfma_f32_16x16x32_bf16 v[108:111], v[72:75], v[36:39], v[108:111]
    ds_read_b64_tr_b16 v[94:95], v15 offset:8192
    v_mfma_f32_16x16x32_bf16 v[104:107], v[76:79], v[40:43], v[104:107]
    ds_read_b64_tr_b16 v[96:97], v15 offset:6144
    v_mfma_f32_16x16x32_bf16 v[108:111], v[76:79], v[44:47], v[108:111]
    ds_read_b64_tr_b16 v[98:99], v14 offset:9216
    v_mfma_f32_16x16x32_bf16 v[104:107], v[80:83], v[48:51], v[104:107]
    ds_read_b64_tr_b16 v[100:101], v14 offset:7168
    v_mfma_f32_16x16x32_bf16 v[108:111], v[80:83], v[52:55], v[108:111]
    ds_read_b64_tr_b16 v[102:103], v15 offset:9216
    s_cmp_eq_u32 s23, 0
    s_cbranch_scc1 Lp1_nw0
    s_add_u32 m0, s21, 131072
    s_mov_b32 s22, 0
    buffer_load_dwordx4 v146, s[16:19], s22 offen lds
Lp1_nw0:
    s_waitcnt lgkmcnt(0)
    v_mfma_f32_16x16x32_bf16 v[112:115], v[84:87], v[16:19], 0
    ds_read_b64_tr_b16 v[64:65], v14 offset:10240
    ds_read_b64_tr_b16 v[66:67], v15 offset:12288
    ds_read_b64_tr_b16 v[68:69], v15 offset:10240
    v_mfma_f32_16x16x32_bf16 v[116:119], v[84:87], v[20:23], 0
    ds_read_b64_tr_b16 v[70:71], v14 offset:13312
    ds_read_b64_tr_b16 v[72:73], v14 offset:11264
    ds_read_b64_tr_b16 v[74:75], v15 offset:13312
    v_mfma_f32_16x16x32_bf16 v[112:115], v[88:91], v[24:27], v[112:115]
    ds_read_b64_tr_b16 v[76:77], v15 offset:11264
    ds_read_b64_tr_b16 v[78:79], v14 offset:14336
    ds_read_b64_tr_b16 v[80:81], v14 offset:12288
    ds_read_b64_tr_b16 v[82:83], v15 offset:14336
    v_mfma_f32_16x16x32_bf16 v[116:119], v[88:91], v[28:31], v[116:119]
    v_fma_f32 v136, v106, v58, v104
    v_fma_f32 v137, v110, v58, v108
    v_mul_f32 v140, v105, v56
    v_mfma_f32_16x16x32_bf16 v[112:115], v[92:95], v[32:35], v[112:115]
    v_mul_f32 v141, v109, v56
    v_fmac_f32 v136, v110, v59
    v_fma_f32 v137, -v106, v59, v137
    v_fmac_f32 v140, v109, v57
    v_mfma_f32_16x16x32_bf16 v[116:119], v[92:95], v[36:39], v[116:119]
    v_fma_f32 v141, -v105, v57, v141
    v_fma_f32 v138, 2.0, v104, -v136
    v_fma_f32 v139, 2.0, v108, -v137
    v_mfma_f32_16x16x32_bf16 v[112:115], v[96:99], v[40:43], v[112:115]
    v_fma_f32 v142, v107, v60, v140
    v_fma_f32 v143, v111, v60, v141
    v_fmac_f32 v142, v111, v61
    v_mfma_f32_16x16x32_bf16 v[116:119], v[96:99], v[44:47], v[116:119]
    v_fma_f32 v143, -v107, v61, v143
    v_fma_f32 v144, 2.0, v140, -v142
    v_fma_f32 v145, 2.0, v141, -v143
    v_add_f32 v120, v136, v142
    v_mfma_f32_16x16x32_bf16 v[112:115], v[100:103], v[48:51], v[112:115]
    v_add_f32 v121, v137, v143
    v_sub_f32 v126, v136, v142
    v_sub_f32 v127, v143, v137
    v_mfma_f32_16x16x32_bf16 v[116:119], v[100:103], v[52:55], v[116:119]
    v_sub_f32 v122, v138, v145
    v_add_f32 v123, v139, v144
    v_add_f32 v124, v138, v145
    v_sub_f32 v125, v139, v144
    s_waitcnt lgkmcnt(0)
    v_mfma_f32_16x16x32_bf16 v[104:107], v[64:67], v[16:19], 0
    ds_read_b64_tr_b16 v[84:85], v14 offset:15360
    ds_read_b64_tr_b16 v[86:87], v15 offset:17408
    ds_read_b64_tr_b16 v[88:89], v15 offset:15360
    ds_read_b64_tr_b16 v[90:91], v14 offset:18432
    v_mfma_f32_16x16x32_bf16 v[108:111], v[64:67], v[20:23], 0
    ds_read_b64_tr_b16 v[92:93], v14 offset:16384
    ds_read_b64_tr_b16 v[94:95], v15 offset:18432
    ds_read_b64_tr_b16 v[96:97], v15 offset:16384
    ds_read_b64_tr_b16 v[98:99], v14 offset:19456
    v_mfma_f32_16x16x32_bf16 v[104:107], v[68:71], v[24:27], v[104:107]
    ds_read_b64_tr_b16 v[100:101], v14 offset:17408
    ds_read_b64_tr_b16 v[102:103], v15 offset:19456
    v_fma_f32 v136, v114, v58, v112
    v_fma_f32 v137, v118, v58, v116
    v_mfma_f32_16x16x32_bf16 v[108:111], v[68:71], v[28:31], v[108:111]
    v_mul_f32 v140, v113, v56
    v_mul_f32 v141, v117, v56
    v_fmac_f32 v136, v118, v59
    v_fma_f32 v137, -v114, v59, v137
    v_fmac_f32 v140, v117, v57
    v_mfma_f32_16x16x32_bf16 v[104:107], v[72:75], v[32:35], v[104:107]
    v_fma_f32 v141, -v113, v57, v141
    v_fma_f32 v138, 2.0, v112, -v136
    v_fma_f32 v139, 2.0, v116, -v137
    v_fma_f32 v142, v115, v60, v140
    v_mfma_f32_16x16x32_bf16 v[108:111], v[72:75], v[36:39], v[108:111]
    v_fma_f32 v143, v119, v60, v141
    v_fmac_f32 v142, v119, v61
    v_fma_f32 v143, -v115, v61, v143
    v_fma_f32 v144, 2.0, v140, -v142
    v_mfma_f32_16x16x32_bf16 v[104:107], v[76:79], v[40:43], v[104:107]
    v_fma_f32 v145, 2.0, v141, -v143
    v_add_f32 v128, v136, v142
    v_add_f32 v129, v137, v143
    v_sub_f32 v134, v136, v142
    v_sub_f32 v135, v143, v137
    v_mfma_f32_16x16x32_bf16 v[108:111], v[76:79], v[44:47], v[108:111]
    v_sub_f32 v130, v138, v145
    v_add_f32 v131, v139, v144
    v_add_f32 v132, v138, v145
    v_sub_f32 v133, v139, v144
    v_mfma_f32_16x16x32_bf16 v[104:107], v[80:83], v[48:51], v[104:107]
    v_cvt_pk_bf16_f32 v152, v120, v128
    v_cvt_pk_bf16_f32 v156, v121, v129
    v_cvt_pk_bf16_f32 v176, v126, v134
    v_cvt_pk_bf16_f32 v180, v127, v135
    v_mfma_f32_16x16x32_bf16 v[108:111], v[80:83], v[52:55], v[108:111]
    v_cvt_pk_bf16_f32 v160, v122, v130
    v_cvt_pk_bf16_f32 v164, -v123, -v131
    v_cvt_pk_bf16_f32 v168, v124, v132
    v_cvt_pk_bf16_f32 v172, v125, v133
    s_cmp_eq_u32 s23, 0
    s_cbranch_scc1 Lp1_nw2
    s_add_u32 m0, s21, 132096
    s_mov_b32 s22, 164352
    buffer_load_dwordx4 v146, s[16:19], s22 offen lds
Lp1_nw2:
    s_waitcnt lgkmcnt(0)
    v_mfma_f32_16x16x32_bf16 v[112:115], v[84:87], v[16:19], 0
    ds_read_b64_tr_b16 v[64:65], v14 offset:20480
    ds_read_b64_tr_b16 v[66:67], v15 offset:22528
    ds_read_b64_tr_b16 v[68:69], v15 offset:20480
    v_mfma_f32_16x16x32_bf16 v[116:119], v[84:87], v[20:23], 0
    ds_read_b64_tr_b16 v[70:71], v14 offset:23552
    ds_read_b64_tr_b16 v[72:73], v14 offset:21504
    ds_read_b64_tr_b16 v[74:75], v15 offset:23552
    v_mfma_f32_16x16x32_bf16 v[112:115], v[88:91], v[24:27], v[112:115]
    ds_read_b64_tr_b16 v[76:77], v15 offset:21504
    ds_read_b64_tr_b16 v[78:79], v14 offset:24576
    ds_read_b64_tr_b16 v[80:81], v14 offset:22528
    ds_read_b64_tr_b16 v[82:83], v15 offset:24576
    v_mfma_f32_16x16x32_bf16 v[116:119], v[88:91], v[28:31], v[116:119]
    v_fma_f32 v136, v106, v58, v104
    v_fma_f32 v137, v110, v58, v108
    v_mul_f32 v140, v105, v56
    v_mfma_f32_16x16x32_bf16 v[112:115], v[92:95], v[32:35], v[112:115]
    v_mul_f32 v141, v109, v56
    v_fmac_f32 v136, v110, v59
    v_fma_f32 v137, -v106, v59, v137
    v_fmac_f32 v140, v109, v57
    v_mfma_f32_16x16x32_bf16 v[116:119], v[92:95], v[36:39], v[116:119]
    v_fma_f32 v141, -v105, v57, v141
    v_fma_f32 v138, 2.0, v104, -v136
    v_fma_f32 v139, 2.0, v108, -v137
    v_mfma_f32_16x16x32_bf16 v[112:115], v[96:99], v[40:43], v[112:115]
    v_fma_f32 v142, v107, v60, v140
    v_fma_f32 v143, v111, v60, v141
    v_fmac_f32 v142, v111, v61
    v_mfma_f32_16x16x32_bf16 v[116:119], v[96:99], v[44:47], v[116:119]
    v_fma_f32 v143, -v107, v61, v143
    v_fma_f32 v144, 2.0, v140, -v142
    v_fma_f32 v145, 2.0, v141, -v143
    v_add_f32 v120, v136, v142
    v_mfma_f32_16x16x32_bf16 v[112:115], v[100:103], v[48:51], v[112:115]
    v_add_f32 v121, v137, v143
    v_sub_f32 v126, v136, v142
    v_sub_f32 v127, v143, v137
    v_mfma_f32_16x16x32_bf16 v[116:119], v[100:103], v[52:55], v[116:119]
    v_sub_f32 v122, v138, v145
    v_add_f32 v123, v139, v144
    v_add_f32 v124, v138, v145
    v_sub_f32 v125, v139, v144
    s_waitcnt lgkmcnt(0)
    v_mfma_f32_16x16x32_bf16 v[104:107], v[64:67], v[16:19], 0
    ds_read_b64_tr_b16 v[84:85], v14 offset:25600
    ds_read_b64_tr_b16 v[86:87], v15 offset:27648
    ds_read_b64_tr_b16 v[88:89], v15 offset:25600
    ds_read_b64_tr_b16 v[90:91], v14 offset:28672
    v_mfma_f32_16x16x32_bf16 v[108:111], v[64:67], v[20:23], 0
    ds_read_b64_tr_b16 v[92:93], v14 offset:26624
    ds_read_b64_tr_b16 v[94:95], v15 offset:28672
    ds_read_b64_tr_b16 v[96:97], v15 offset:26624
    ds_read_b64_tr_b16 v[98:99], v14 offset:29696
    v_mfma_f32_16x16x32_bf16 v[104:107], v[68:71], v[24:27], v[104:107]
    ds_read_b64_tr_b16 v[100:101], v14 offset:27648
    ds_read_b64_tr_b16 v[102:103], v15 offset:29696
    v_fma_f32 v136, v114, v58, v112
    v_fma_f32 v137, v118, v58, v116
    v_mfma_f32_16x16x32_bf16 v[108:111], v[68:71], v[28:31], v[108:111]
    v_mul_f32 v140, v113, v56
    v_mul_f32 v141, v117, v56
    v_fmac_f32 v136, v118, v59
    v_fma_f32 v137, -v114, v59, v137
    v_fmac_f32 v140, v117, v57
    v_mfma_f32_16x16x32_bf16 v[104:107], v[72:75], v[32:35], v[104:107]
    v_fma_f32 v141, -v113, v57, v141
    v_fma_f32 v138, 2.0, v112, -v136
    v_fma_f32 v139, 2.0, v116, -v137
    v_fma_f32 v142, v115, v60, v140
    v_mfma_f32_16x16x32_bf16 v[108:111], v[72:75], v[36:39], v[108:111]
    v_fma_f32 v143, v119, v60, v141
    v_fmac_f32 v142, v119, v61
    v_fma_f32 v143, -v115, v61, v143
    v_fma_f32 v144, 2.0, v140, -v142
    v_mfma_f32_16x16x32_bf16 v[104:107], v[76:79], v[40:43], v[104:107]
    v_fma_f32 v145, 2.0, v141, -v143
    v_add_f32 v128, v136, v142
    v_add_f32 v129, v137, v143
    v_sub_f32 v134, v136, v142
    v_sub_f32 v135, v143, v137
    v_mfma_f32_16x16x32_bf16 v[108:111], v[76:79], v[44:47], v[108:111]
    v_sub_f32 v130, v138, v145
    v_add_f32 v131, v139, v144
    v_add_f32 v132, v138, v145
    v_sub_f32 v133, v139, v144
    v_mfma_f32_16x16x32_bf16 v[104:107], v[80:83], v[48:51], v[104:107]
    v_cvt_pk_bf16_f32 v153, v120, v128
    v_cvt_pk_bf16_f32 v157, v121, v129
    v_cvt_pk_bf16_f32 v177, v126, v134
    v_cvt_pk_bf16_f32 v181, v127, v135
    v_mfma_f32_16x16x32_bf16 v[108:111], v[80:83], v[52:55], v[108:111]
    v_cvt_pk_bf16_f32 v161, v122, v130
    v_cvt_pk_bf16_f32 v165, -v123, -v131
    v_cvt_pk_bf16_f32 v169, v124, v132
    v_cvt_pk_bf16_f32 v173, v125, v133
    s_cmp_eq_u32 s23, 0
    s_cbranch_scc1 Lp1_nw4
    s_add_u32 m0, s21, 133120
    s_mov_b32 s22, 328704
    buffer_load_dwordx4 v146, s[16:19], s22 offen lds
Lp1_nw4:
    s_waitcnt lgkmcnt(0)
    v_mfma_f32_16x16x32_bf16 v[112:115], v[84:87], v[16:19], 0
    ds_read_b64_tr_b16 v[64:65], v14 offset:30720
    ds_read_b64_tr_b16 v[66:67], v15 offset:32768
    ds_read_b64_tr_b16 v[68:69], v15 offset:30720
    v_mfma_f32_16x16x32_bf16 v[116:119], v[84:87], v[20:23], 0
    ds_read_b64_tr_b16 v[70:71], v14 offset:33792
    ds_read_b64_tr_b16 v[72:73], v14 offset:31744
    ds_read_b64_tr_b16 v[74:75], v15 offset:33792
    v_mfma_f32_16x16x32_bf16 v[112:115], v[88:91], v[24:27], v[112:115]
    ds_read_b64_tr_b16 v[76:77], v15 offset:31744
    ds_read_b64_tr_b16 v[78:79], v14 offset:34816
    ds_read_b64_tr_b16 v[80:81], v14 offset:32768
    ds_read_b64_tr_b16 v[82:83], v15 offset:34816
    v_mfma_f32_16x16x32_bf16 v[116:119], v[88:91], v[28:31], v[116:119]
    v_fma_f32 v136, v106, v58, v104
    v_fma_f32 v137, v110, v58, v108
    v_mul_f32 v140, v105, v56
    v_mfma_f32_16x16x32_bf16 v[112:115], v[92:95], v[32:35], v[112:115]
    v_mul_f32 v141, v109, v56
    v_fmac_f32 v136, v110, v59
    v_fma_f32 v137, -v106, v59, v137
    v_fmac_f32 v140, v109, v57
    v_mfma_f32_16x16x32_bf16 v[116:119], v[92:95], v[36:39], v[116:119]
    v_fma_f32 v141, -v105, v57, v141
    v_fma_f32 v138, 2.0, v104, -v136
    v_fma_f32 v139, 2.0, v108, -v137
    v_mfma_f32_16x16x32_bf16 v[112:115], v[96:99], v[40:43], v[112:115]
    v_fma_f32 v142, v107, v60, v140
    v_fma_f32 v143, v111, v60, v141
    v_fmac_f32 v142, v111, v61
    v_mfma_f32_16x16x32_bf16 v[116:119], v[96:99], v[44:47], v[116:119]
    v_fma_f32 v143, -v107, v61, v143
    v_fma_f32 v144, 2.0, v140, -v142
    v_fma_f32 v145, 2.0, v141, -v143
    v_add_f32 v120, v136, v142
    v_mfma_f32_16x16x32_bf16 v[112:115], v[100:103], v[48:51], v[112:115]
    v_add_f32 v121, v137, v143
    v_sub_f32 v126, v136, v142
    v_sub_f32 v127, v143, v137
    v_mfma_f32_16x16x32_bf16 v[116:119], v[100:103], v[52:55], v[116:119]
    v_sub_f32 v122, v138, v145
    v_add_f32 v123, v139, v144
    v_add_f32 v124, v138, v145
    v_sub_f32 v125, v139, v144
    s_waitcnt lgkmcnt(0)
    v_mfma_f32_16x16x32_bf16 v[104:107], v[64:67], v[16:19], 0
    ds_read_b64_tr_b16 v[84:85], v14 offset:35840
    ds_read_b64_tr_b16 v[86:87], v15 offset:37888
    ds_read_b64_tr_b16 v[88:89], v15 offset:35840
    ds_read_b64_tr_b16 v[90:91], v14 offset:38912
    v_mfma_f32_16x16x32_bf16 v[108:111], v[64:67], v[20:23], 0
    ds_read_b64_tr_b16 v[92:93], v14 offset:36864
    ds_read_b64_tr_b16 v[94:95], v15 offset:38912
    ds_read_b64_tr_b16 v[96:97], v15 offset:36864
    ds_read_b64_tr_b16 v[98:99], v14 offset:39936
    v_mfma_f32_16x16x32_bf16 v[104:107], v[68:71], v[24:27], v[104:107]
    ds_read_b64_tr_b16 v[100:101], v14 offset:37888
    ds_read_b64_tr_b16 v[102:103], v15 offset:39936
    v_fma_f32 v136, v114, v58, v112
    v_fma_f32 v137, v118, v58, v116
    v_mfma_f32_16x16x32_bf16 v[108:111], v[68:71], v[28:31], v[108:111]
    v_mul_f32 v140, v113, v56
    v_mul_f32 v141, v117, v56
    v_fmac_f32 v136, v118, v59
    v_fma_f32 v137, -v114, v59, v137
    v_fmac_f32 v140, v117, v57
    v_mfma_f32_16x16x32_bf16 v[104:107], v[72:75], v[32:35], v[104:107]
    v_fma_f32 v141, -v113, v57, v141
    v_fma_f32 v138, 2.0, v112, -v136
    v_fma_f32 v139, 2.0, v116, -v137
    v_fma_f32 v142, v115, v60, v140
    v_mfma_f32_16x16x32_bf16 v[108:111], v[72:75], v[36:39], v[108:111]
    v_fma_f32 v143, v119, v60, v141
    v_fmac_f32 v142, v119, v61
    v_fma_f32 v143, -v115, v61, v143
    v_fma_f32 v144, 2.0, v140, -v142
    v_mfma_f32_16x16x32_bf16 v[104:107], v[76:79], v[40:43], v[104:107]
    v_fma_f32 v145, 2.0, v141, -v143
    v_add_f32 v128, v136, v142
    v_add_f32 v129, v137, v143
    v_sub_f32 v134, v136, v142
    v_sub_f32 v135, v143, v137
    v_mfma_f32_16x16x32_bf16 v[108:111], v[76:79], v[44:47], v[108:111]
    v_sub_f32 v130, v138, v145
    v_add_f32 v131, v139, v144
    v_add_f32 v132, v138, v145
    v_sub_f32 v133, v139, v144
    v_mfma_f32_16x16x32_bf16 v[104:107], v[80:83], v[48:51], v[104:107]
    v_cvt_pk_bf16_f32 v154, v120, v128
    v_cvt_pk_bf16_f32 v158, v121, v129
    v_cvt_pk_bf16_f32 v178, v126, v134
    v_cvt_pk_bf16_f32 v182, v127, v135
    v_mfma_f32_16x16x32_bf16 v[108:111], v[80:83], v[52:55], v[108:111]
    v_cvt_pk_bf16_f32 v162, v122, v130
    v_cvt_pk_bf16_f32 v166, -v123, -v131
    v_cvt_pk_bf16_f32 v170, v124, v132
    v_cvt_pk_bf16_f32 v174, v125, v133
    s_cmp_eq_u32 s23, 0
    s_cbranch_scc1 Lp1_nw6
    s_add_u32 m0, s21, 134144
    s_mov_b32 s22, 493056
    buffer_load_dwordx4 v146, s[16:19], s22 offen lds
Lp1_nw6:
    s_waitcnt lgkmcnt(0)
    v_mfma_f32_16x16x32_bf16 v[112:115], v[84:87], v[16:19], 0
    ds_read_b128 v[184:187], v7 offset:0
    ds_read_b128 v[188:191], v7 offset:1024
    ds_read_b128 v[192:195], v7 offset:2048
    v_mfma_f32_16x16x32_bf16 v[116:119], v[84:87], v[20:23], 0
    ds_read_b128 v[196:199], v7 offset:3072
    ds_read_b128 v[200:203], v7 offset:4096
    ds_read_b128 v[204:207], v7 offset:5120
    v_mfma_f32_16x16x32_bf16 v[112:115], v[88:91], v[24:27], v[112:115]
    v_fma_f32 v136, v106, v58, v104
    v_fma_f32 v137, v110, v58, v108
    v_mul_f32 v140, v105, v56
    v_mfma_f32_16x16x32_bf16 v[116:119], v[88:91], v[28:31], v[116:119]
    v_mul_f32 v141, v109, v56
    v_fmac_f32 v136, v110, v59
    v_fma_f32 v137, -v106, v59, v137
    v_mfma_f32_16x16x32_bf16 v[112:115], v[92:95], v[32:35], v[112:115]
    v_fmac_f32 v140, v109, v57
    v_fma_f32 v141, -v105, v57, v141
    v_fma_f32 v138, 2.0, v104, -v136
    v_mfma_f32_16x16x32_bf16 v[116:119], v[92:95], v[36:39], v[116:119]
    v_fma_f32 v139, 2.0, v108, -v137
    v_fma_f32 v142, v107, v60, v140
    v_fma_f32 v143, v111, v60, v141
    v_mfma_f32_16x16x32_bf16 v[112:115], v[96:99], v[40:43], v[112:115]
    v_fmac_f32 v142, v111, v61
    v_fma_f32 v143, -v107, v61, v143
    v_fma_f32 v144, 2.0, v140, -v142
    v_mfma_f32_16x16x32_bf16 v[116:119], v[96:99], v[44:47], v[116:119]
    v_fma_f32 v145, 2.0, v141, -v143
    v_add_f32 v120, v136, v142
    v_add_f32 v121, v137, v143
    v_mfma_f32_16x16x32_bf16 v[112:115], v[100:103], v[48:51], v[112:115]
    v_sub_f32 v126, v136, v142
    v_sub_f32 v127, v143, v137
    v_sub_f32 v122, v138, v145
    v_mfma_f32_16x16x32_bf16 v[116:119], v[100:103], v[52:55], v[116:119]
    v_add_f32 v123, v139, v144
    v_add_f32 v124, v138, v145
    v_sub_f32 v125, v139, v144
    s_nop 0
    v_fma_f32 v136, v114, v58, v112
    s_nop 2
    v_fma_f32 v137, v118, v58, v116
    v_mul_f32 v140, v113, v56
    v_mul_f32 v141, v117, v56
    v_fmac_f32 v136, v118, v59
    v_fma_f32 v137, -v114, v59, v137
    v_fmac_f32 v140, v117, v57
    v_fma_f32 v141, -v113, v57, v141
    v_fma_f32 v138, 2.0, v112, -v136
    v_fma_f32 v139, 2.0, v116, -v137
    v_fma_f32 v142, v115, v60, v140
    v_fma_f32 v143, v119, v60, v141
    v_fmac_f32 v142, v119, v61
    v_fma_f32 v143, -v115, v61, v143
    v_fma_f32 v144, 2.0, v140, -v142
    v_fma_f32 v145, 2.0, v141, -v143
    v_add_f32 v128, v136, v142
    v_add_f32 v129, v137, v143
    v_sub_f32 v134, v136, v142
    v_sub_f32 v135, v143, v137
    v_sub_f32 v130, v138, v145
    v_add_f32 v131, v139, v144
    v_add_f32 v132, v138, v145
    v_sub_f32 v133, v139, v144
    v_cvt_pk_bf16_f32 v155, v120, v128
    s_cmp_lg_u32 s43, 0
    s_cbranch_scc1 Lp1_nodc
    s_mov_b32 exec_lo, 0x10001
    s_mov_b32 exec_hi, 0x10001
    ds_read_b128 v[152:155], v62
    s_mov_b64 exec, -1
Lp1_nodc:
    v_cvt_pk_bf16_f32 v159, v121, v129
    v_cvt_pk_bf16_f32 v179, v126, v134
    v_cvt_pk_bf16_f32 v183, v127, v135
    v_cvt_pk_bf16_f32 v163, v122, v130
    v_cvt_pk_bf16_f32 v167, -v123, -v131
    v_cvt_pk_bf16_f32 v171, v124, v132
    v_cvt_pk_bf16_f32 v175, v125, v133
    s_add_u32 s41, s29, s44
    s_lshl_b32 s41, s41, 7
    s_lshl_b32 s42, s43, 13
    s_add_u32 s41, s41, s42
    v_mov_b32 v150, 0
    buffer_load_dwordx2 v[148:149], v150, s[56:59], 0 offen sc1
    s_waitcnt lgkmcnt(0)
    v_mfma_f32_16x16x32_bf16 v[208:211], v[152:155], v[184:187], 0
    v_mfma_f32_16x16x32_bf16 v[212:215], v[156:159], v[184:187], 0
    v_mfma_f32_16x16x32_bf16 v[208:211], v[156:159], v[188:191], v[208:211]
    v_mfma_f32_16x16x32_bf16 v[212:215], v[152:155], v[192:195], v[212:215]
    v_mfma_f32_16x16x32_bf16 v[216:219], v[152:155], v[196:199], 0
    v_mfma_f32_16x16x32_bf16 v[220:223], v[156:159], v[196:199], 0
    v_mfma_f32_16x16x32_bf16 v[216:219], v[156:159], v[200:203], v[216:219]
    v_mfma_f32_16x16x32_bf16 v[220:223], v[152:155], v[204:207], v[220:223]
    v_mfma_f32_16x16x32_bf16 v[224:227], v[168:171], v[184:187], 0
    v_mfma_f32_16x16x32_bf16 v[228:231], v[172:175], v[184:187], 0
    v_mfma_f32_16x16x32_bf16 v[224:227], v[172:175], v[188:191], v[224:227]
    v_mfma_f32_16x16x32_bf16 v[228:231], v[168:171], v[192:195], v[228:231]
    v_mfma_f32_16x16x32_bf16 v[232:235], v[168:171], v[196:199], 0
    v_mfma_f32_16x16x32_bf16 v[236:239], v[172:175], v[196:199], 0
    v_mfma_f32_16x16x32_bf16 v[232:235], v[172:175], v[200:203], v[232:235]
    v_mfma_f32_16x16x32_bf16 v[236:239], v[168:171], v[204:207], v[236:239]
    s_cmp_eq_u32 s43, 5
    s_cbranch_scc1 Lp1_b5
    v_mfma_f32_16x16x32_bf16 v[64:67], v[160:163], v[184:187], 0
    v_cvt_pk_bf16_f32 v240, v208, v209
    v_mfma_f32_16x16x32_bf16 v[68:71], v[164:167], v[184:187], 0
    v_cvt_pk_bf16_f32 v241, v210, v211
    v_cvt_pk_bf16_f32 v242, v212, v213
    v_mfma_f32_16x16x32_bf16 v[64:67], v[164:167], v[188:191], v[64:67]
    v_cvt_pk_bf16_f32 v243, v214, v215
    v_mfma_f32_16x16x32_bf16 v[68:71], v[160:163], v[192:195], v[68:71]
    ds_write_b128 v5, v[240:243] offset:0
    v_cvt_pk_bf16_f32 v244, v216, v217
    v_mfma_f32_16x16x32_bf16 v[72:75], v[160:163], v[196:199], 0
    v_cvt_pk_bf16_f32 v245, v218, v219
    v_mfma_f32_16x16x32_bf16 v[76:79], v[164:167], v[196:199], 0
    v_cvt_pk_bf16_f32 v246, v220, v221
    v_cvt_pk_bf16_f32 v247, v222, v223
    v_mfma_f32_16x16x32_bf16 v[72:75], v[164:167], v[200:203], v[72:75]
    ds_write_b128 v5, v[244:247] offset:2048
    v_mfma_f32_16x16x32_bf16 v[76:79], v[160:163], v[204:207], v[76:79]
    v_cvt_pk_bf16_f32 v248, v224, v225
    v_cvt_pk_bf16_f32 v249, v226, v227
    v_mfma_f32_16x16x32_bf16 v[80:83], v[176:179], v[184:187], 0
    v_cvt_pk_bf16_f32 v250, v228, v229
    v_mfma_f32_16x16x32_bf16 v[84:87], v[180:183], v[184:187], 0
    v_cvt_pk_bf16_f32 v251, v230, v231
    ds_write_b128 v6, v[248:251] offset:0
    v_mfma_f32_16x16x32_bf16 v[80:83], v[180:183], v[188:191], v[80:83]
    v_cvt_pk_bf16_f32 v252, v232, v233
    v_mfma_f32_16x16x32_bf16 v[84:87], v[176:179], v[192:195], v[84:87]
    v_cvt_pk_bf16_f32 v253, v234, v235
    v_cvt_pk_bf16_f32 v254, v236, v237
    v_mfma_f32_16x16x32_bf16 v[88:91], v[176:179], v[196:199], 0
    v_cvt_pk_bf16_f32 v255, v238, v239
    v_mfma_f32_16x16x32_bf16 v[92:95], v[180:183], v[196:199], 0
    ds_write_b128 v6, v[252:255] offset:2048
    ds_read_b128 v[208:211], v3 offset:0
    v_mfma_f32_16x16x32_bf16 v[88:91], v[180:183], v[200:203], v[88:91]
    ds_read_b128 v[212:215], v3 offset:1024
    v_mfma_f32_16x16x32_bf16 v[92:95], v[176:179], v[204:207], v[92:95]
    ds_read_b128 v[216:219], v3 offset:2048
    ds_read_b128 v[220:223], v3 offset:3072
    s_add_u32 s42, s41, 0
    s_waitcnt lgkmcnt(3)
    buffer_store_dwordx4 v[208:211], v63, s[36:39], s42 offen sc1
    s_add_u32 s42, s41, 720896
    s_waitcnt lgkmcnt(2)
    buffer_store_dwordx4 v[212:215], v63, s[36:39], s42 offen sc1
    s_add_u32 s42, s41, 1441792
    s_waitcnt lgkmcnt(1)
    buffer_store_dwordx4 v[216:219], v63, s[36:39], s42 offen sc1
    s_add_u32 s42, s41, 2162688
    s_waitcnt lgkmcnt(0)
    buffer_store_dwordx4 v[220:223], v63, s[36:39], s42 offen sc1
    v_cvt_pk_bf16_f32 v240, v64, v65
    v_cvt_pk_bf16_f32 v241, v66, v67
    v_cvt_pk_bf16_f32 v242, v68, v69
    v_cvt_pk_bf16_f32 v243, v70, v71
    ds_write_b128 v5, v[240:243] offset:0
    v_cvt_pk_bf16_f32 v244, v72, v73
    v_cvt_pk_bf16_f32 v245, v74, v75
    v_cvt_pk_bf16_f32 v246, v76, v77
    v_cvt_pk_bf16_f32 v247, v78, v79
    ds_write_b128 v5, v[244:247] offset:2048
    v_cvt_pk_bf16_f32 v248, v80, v81
    v_cvt_pk_bf16_f32 v249, v82, v83
    v_cvt_pk_bf16_f32 v250, v84, v85
    v_cvt_pk_bf16_f32 v251, v86, v87
    ds_write_b128 v6, v[248:251] offset:0
    v_cvt_pk_bf16_f32 v252, v88, v89
    v_cvt_pk_bf16_f32 v253, v90, v91
    v_cvt_pk_bf16_f32 v254, v92, v93
    v_cvt_pk_bf16_f32 v255, v94, v95
    ds_write_b128 v6, v[252:255] offset:2048
    ds_read_b128 v[64:67], v3 offset:0
    ds_read_b128 v[68:71], v3 offset:1024
    ds_read_b128 v[72:75], v3 offset:2048
    ds_read_b128 v[76:79], v3 offset:3072
    s_add_u32 s42, s41, 49152
    s_waitcnt lgkmcnt(3)
    buffer_store_dwordx4 v[64:67], v63, s[36:39], s42 offen sc1
    s_add_u32 s42, s41, 770048
    s_waitcnt lgkmcnt(2)
    buffer_store_dwordx4 v[68:71], v63, s[36:39], s42 offen sc1
    s_add_u32 s42, s41, 1490944
    s_waitcnt lgkmcnt(1)
    buffer_store_dwordx4 v[72:75], v63, s[36:39], s42 offen sc1
    s_add_u32 s42, s41, 2211840
    s_waitcnt lgkmcnt(0)
    buffer_store_dwordx4 v[76:79], v63, s[36:39], s42 offen sc1
    s_cmp_eq_u32 s45, 0
    s_cbranch_scc1 Lp1_done
    s_mov_b32 s45, 0
    s_mov_b32 s44, 1
    v_add_u32 v14, 40960, v14
    v_add_u32 v15, 40960, v15
    v_add_u32 v7, 6144, v7
    v_add_u32 v62, 64, v62
    s_mov_b32 s23, 0
    s_branch Lp1_unit
Lp1_b5:
    s_nop 7
    v_cvt_pk_bf16_f32 v240, v208, v209
    v_cvt_pk_bf16_f32 v241, v210, v211
    v_cvt_pk_bf16_f32 v242, v212, v213
    v_cvt_pk_bf16_f32 v243, v214, v215
    ds_write_b128 v5, v[240:243] offset:0
    v_cvt_pk_bf16_f32 v244, v216, v217
    v_cvt_pk_bf16_f32 v245, v218, v219
    v_cvt_pk_bf16_f32 v246, v220, v221
    v_cvt_pk_bf16_f32 v247, v222, v223
    ds_write_b128 v5, v[244:247] offset:2048
    v_cvt_pk_bf16_f32 v248, v224, v225
    v_cvt_pk_bf16_f32 v249, v226, v227
    v_cvt_pk_bf16_f32 v250, v228, v229
    v_cvt_pk_bf16_f32 v251, v230, v231
    ds_write_b128 v6, v[248:251] offset:0
    v_cvt_pk_bf16_f32 v252, v232, v233
    v_cvt_pk_bf16_f32 v253, v234, v235
    v_cvt_pk_bf16_f32 v254, v236, v237
    v_cvt_pk_bf16_f32 v255, v238, v239
    ds_write_b128 v6, v[252:255] offset:2048
    ds_read_b128 v[208:211], v3 offset:0
    ds_read_b128 v[212:215], v3 offset:1024
    ds_read_b128 v[216:219], v3 offset:2048
    ds_read_b128 v[220:223], v3 offset:3072
    s_add_u32 s42, s41, 0
    s_waitcnt lgkmcnt(3)
    buffer_store_dwordx4 v[208:211], v63, s[36:39], s42 offen sc1
    s_add_u32 s42, s41, 720896
    s_waitcnt lgkmcnt(2)
    buffer_store_dwordx4 v[212:215], v63, s[36:39], s42 offen sc1
    s_add_u32 s42, s41, 1441792
    s_waitcnt lgkmcnt(1)
    buffer_store_dwordx4 v[216:219], v63, s[36:39], s42 offen sc1
    s_add_u32 s42, s41, 2162688
    s_waitcnt lgkmcnt(0)
    buffer_store_dwordx4 v[220:223], v63, s[36:39], s42 offen sc1
Lp1_done:
    s_lshl_b32 s42, s29, 6
    s_add_u32 s42, s42, 65536
    s_mov_b32 s51, 2
    s_lshr_b32 s50, s29, 1
    s_nop 1
Lp2:
    s_sub_u32 s33, s32, 20
    s_mul_i32 s34, s33, 43
    s_lshr_b32 s34, s34, 7
    s_mul_i32 s35, s34, 3
    s_sub_u32 s45, s33, s35
    s_lshl_b32 s29, s31, 2
    s_add_u32 s29, s29, s34
    s_and_b32 s46, s28, 3
    s_mov_b32 s34, 0x9a543210
    s_mov_b32 s35, 0x8876
    s_lshl_b32 s33, s45, 2
    s_add_u32 s33, s33, s46
    s_lshl_b32 s33, s33, 2
    s_lshr_b64 s[34:35], s[34:35], s33
    s_and_b32 s30, s34, 15
    s_lshl_b32 s47, s45, 6
    s_cmp_eq_u32 s45, 2
    s_cselect_b32 s47, 113, s47
    s_mul_i32 s43, s29, 90112
    s_lshl_b32 s34, s30, 13
    s_add_u32 s43, s43, s34
    s_lshr_b32 s34, s28, 2
    s_lshl_b32 s34, s34, 12
    s_add_u32 s43, s43, s34
    s_lshl_b32 s35, s46, 13
    s_add_u32 s44, s35, s34
    s_cmp_lg_u32 s51, 0
    s_cbranch_scc1 Lp2_r1
    s_load_dwordx4 s[24:27], s[0:1], 8
    s_sub_u32 s20, s32, 20
    s_mul_i32 s21, s20, 43
    s_lshr_b32 s21, s21, 7
    s_mul_i32 s22, s21, 3
    s_sub_u32 s22, s20, s22
    s_lshl_b32 s20, s31, 2
    s_add_u32 s20, s20, s21
    s_lshl_b32 s23, s22, 7
    s_cmp_eq_u32 s22, 2
    s_cselect_b32 s23, 226, s23
    v_lshrrev_b32 v8, 3, v0
    v_lshl_add_u32 v8, v8, 5, s20
    v_mul_u32_u24 v8, 642, v8
    v_and_b32 v9, 7, v0
    v_lshl_add_u32 v8, v9, 4, v8
    s_bfe_u32 s21, s28, 0x10001
    s_mulk_i32 s21, 320
    s_add_u32 s23, s23, s21
    s_and_b32 s21, s28, 1
    s_mul_i32 s21, s21, 657408
    s_add_u32 s23, s23, s21
    v_add_u32 v8, s23, v8
    s_lshl_b32 s21, s28, 12
    s_waitcnt lgkmcnt(0)
    s_cmp_lt_u32 s28, 4
    s_cselect_b32 s16, s24, s26
    s_cselect_b32 s17, s25, s27
    s_mov_b32 s18, 1314816
    s_mov_b32 s19, 0x00020000
    s_barrier
    s_cmp_lt_u32 s28, 4
    s_cbranch_scc1 Lp2_r1
    s_add_u32 m0, s21, 131072
    s_mov_b32 s22, 0
    buffer_load_dwordx4 v8, s[16:19], s22 offen lds
    s_add_u32 m0, s21, 132096
    s_mov_b32 s22, 164352
    buffer_load_dwordx4 v8, s[16:19], s22 offen lds
    s_add_u32 m0, s21, 133120
    s_mov_b32 s22, 328704
    buffer_load_dwordx4 v8, s[16:19], s22 offen lds
    s_add_u32 m0, s21, 134144
    s_mov_b32 s22, 493056
    buffer_load_dwordx4 v8, s[16:19], s22 offen lds
    s_mov_b32 s16, s24
    s_mov_b32 s17, s25
    s_sub_u32 s21, s21, 16384
    s_add_u32 m0, s21, 131072
    s_mov_b32 s22, 0
    buffer_load_dwordx4 v8, s[16:19], s22 offen lds
    s_add_u32 m0, s21, 132096
    s_mov_b32 s22, 164352
    buffer_load_dwordx4 v8, s[16:19], s22 offen lds
    s_add_u32 m0, s21, 133120
    s_mov_b32 s22, 328704
    buffer_load_dwordx4 v8, s[16:19], s22 offen lds
    s_add_u32 m0, s21, 134144
    s_mov_b32 s22, 493056
    buffer_load_dwordx4 v8, s[16:19], s22 offen lds
Lp2_r1:
    v_and_b32 v1, 15, v0
    v_lshrrev_b32 v2, 4, v0
    v_cvt_f32_u32 v7, v2
    v_mul_f32 v7, 4.0, v7
    v_cvt_f32_u32 v5, v1
    v_mul_f32 v5, 0x3c800000, v5
    v_add_f32 v6, 0x3e800000, v5
    v_and_b32 v14, 1, v0
    v_mov_b32 v15, 0x80008000
    v_mul_lo_u32 v14, v14, v15
    v_xor_b32 v15, 0x80000000, v14
    v_mul_f32 v3, v7, v5
    v_fmamk_f32 v8, v5, 0x00000000, v3
    v_fmamk_f32 v9, v5, 0x3f800000, v3
    v_cos_f32 v10, v8
    v_cos_f32 v11, v9
    v_sin_f32 v12, v8
    v_sin_f32 v13, v9
    v_cvt_pk_bf16_f32 v16, v10, v11
    v_cvt_pk_bf16_f32 v48, v12, v13
    v_xor_b32 v20, v14, v16
    v_xor_b32 v32, 0x80000000, v16
    v_xor_b32 v36, v15, v16
    v_xor_b32 v52, v14, v48
    v_xor_b32 v64, 0x80000000, v48
    v_xor_b32 v68, v15, v48
    v_fmamk_f32 v8, v5, 0x40000000, v3
    v_fmamk_f32 v9, v5, 0x40400000, v3
    v_cos_f32 v10, v8
    v_cos_f32 v11, v9
    v_sin_f32 v12, v8
    v_sin_f32 v13, v9
    v_cvt_pk_bf16_f32 v17, v10, v11
    v_cvt_pk_bf16_f32 v49, v12, v13
    v_xor_b32 v21, v14, v17
    v_xor_b32 v33, 0x80000000, v17
    v_xor_b32 v37, v15, v17
    v_xor_b32 v53, v14, v49
    v_xor_b32 v65, 0x80000000, v49
    v_xor_b32 v69, v15, v49
    v_fmamk_f32 v8, v5, 0x41800000, v3
    v_fmamk_f32 v9, v5, 0x41880000, v3
    v_cos_f32 v10, v8
    v_cos_f32 v11, v9
    v_sin_f32 v12, v8
    v_sin_f32 v13, v9
    v_cvt_pk_bf16_f32 v18, v10, v11
    v_cvt_pk_bf16_f32 v50, v12, v13
    v_xor_b32 v22, v14, v18
    v_xor_b32 v34, 0x80000000, v18
    v_xor_b32 v38, v15, v18
    v_xor_b32 v54, v14, v50
    v_xor_b32 v66, 0x80000000, v50
    v_xor_b32 v70, v15, v50
    v_fmamk_f32 v8, v5, 0x41900000, v3
    v_fmamk_f32 v9, v5, 0x41980000, v3
    v_cos_f32 v10, v8
    v_cos_f32 v11, v9
    v_sin_f32 v12, v8
    v_sin_f32 v13, v9
    v_cvt_pk_bf16_f32 v19, v10, v11
    v_cvt_pk_bf16_f32 v51, v12, v13
    v_xor_b32 v23, v14, v19
    v_xor_b32 v35, 0x80000000, v19
    v_xor_b32 v39, v15, v19
    v_xor_b32 v55, v14, v51
    v_xor_b32 v67, 0x80000000, v51
    v_xor_b32 v71, v15, v51
    v_mul_f32 v3, v7, v6
    v_fmamk_f32 v8, v6, 0x00000000, v3
    v_fmamk_f32 v9, v6, 0x3f800000, v3
    v_cos_f32 v10, v8
    v_cos_f32 v11, v9
    v_sin_f32 v12, v8
    v_sin_f32 v13, v9
    v_cvt_pk_bf16_f32 v24, v10, v11
    v_cvt_pk_bf16_f32 v56, v12, v13
    v_xor_b32 v28, v14, v24
    v_xor_b32 v40, 0x80000000, v24
    v_xor_b32 v44, v15, v24
    v_xor_b32 v60, v14, v56
    v_xor_b32 v72, 0x80000000, v56
    v_xor_b32 v76, v15, v56
    v_fmamk_f32 v8, v6, 0x40000000, v3
    v_fmamk_f32 v9, v6, 0x40400000, v3
    v_cos_f32 v10, v8
    v_cos_f32 v11, v9
    v_sin_f32 v12, v8
    v_sin_f32 v13, v9
    v_cvt_pk_bf16_f32 v25, v10, v11
    v_cvt_pk_bf16_f32 v57, v12, v13
    v_xor_b32 v29, v14, v25
    v_xor_b32 v41, 0x80000000, v25
    v_xor_b32 v45, v15, v25
    v_xor_b32 v61, v14, v57
    v_xor_b32 v73, 0x80000000, v57
    v_xor_b32 v77, v15, v57
    v_fmamk_f32 v8, v6, 0x41800000, v3
    v_fmamk_f32 v9, v6, 0x41880000, v3
    v_cos_f32 v10, v8
    v_cos_f32 v11, v9
    v_sin_f32 v12, v8
    v_sin_f32 v13, v9
    v_cvt_pk_bf16_f32 v26, v10, v11
    v_cvt_pk_bf16_f32 v58, v12, v13
    v_xor_b32 v30, v14, v26
    v_xor_b32 v42, 0x80000000, v26
    v_xor_b32 v46, v15, v26
    v_xor_b32 v62, v14, v58
    v_xor_b32 v74, 0x80000000, v58
    v_xor_b32 v78, v15, v58
    v_fmamk_f32 v8, v6, 0x41900000, v3
    v_fmamk_f32 v9, v6, 0x41980000, v3
    v_cos_f32 v10, v8
    v_cos_f32 v11, v9
    v_sin_f32 v12, v8
    v_sin_f32 v13, v9
    v_cvt_pk_bf16_f32 v27, v10, v11
    v_cvt_pk_bf16_f32 v59, v12, v13
    v_xor_b32 v31, v14, v27
    v_xor_b32 v43, 0x80000000, v27
    v_xor_b32 v47, v15, v27
    v_xor_b32 v63, v14, v59
    v_xor_b32 v75, 0x80000000, v59
    v_xor_b32 v79, v15, v59
    v_lshlrev_b32 v253, 7, v0
    s_lshl_b32 s37, s31, 12
    s_add_u32 s37, s37, 65536
    s_mov_b32 s38, -1
    s_mov_b32 s39, 0
    s_cmp_eq_u32 s51, 0
    s_cbranch_scc1 Lp2_r2
    s_waitcnt vmcnt(0)
    s_cmp_lg_u32 s51, 2
    s_cbranch_scc1 Lp2_r2
    v_mov_b32 v150, 0
    s_mov_b32 s3, 0
Lcc5:
    v_readfirstlane_b32 s49, v148
    s_add_u32 s3, s3, 1
    s_cmp_lg_u32 s49, 0
    s_cbranch_scc1 Lcd5
    s_cmp_ge_u32 s3, 131072
    s_cbranch_scc1 Lcd5
    buffer_load_dwordx2 v[148:149], v150, s[56:59], 0 offen sc1
    s_waitcnt vmcnt(0)
    s_branch Lcc5
Lcd5:
    v_readfirstlane_b32 s98, v148
    v_readfirstlane_b32 s99, v149
    s_bitset0_b32 s38, s50
Lp2_r2:
    v_lshrrev_b32 v10, 3, v0
    v_lshlrev_b32 v10, 12, v10
    v_and_b32 v11, 7, v0
    v_lshl_add_u32 v10, v11, 4, v10
    v_mov_b32 v248, s98
    v_mov_b32 v249, s99
    v_mov_b32 v250, s98
    v_mov_b32 v251, s99
    s_barrier
    s_cmp_lg_u32 s28, 0
    s_cbranch_scc1 Lp2_r3
    s_cmp_eq_u32 s51, 2
    s_cselect_b64 exec, -1, 0xff
    buffer_store_dwordx4 v[248:251], v10, s[52:55], s42 offen sc1
    s_mov_b64 exec, -1
Lp2_r3:
    s_mov_b32 s3, 0
    s_cmp_lg_u32 s28, 2
    s_cbranch_scc1 Lp2_np
    s_mov_b64 exec, s[38:39]
    v_mov_b32 v254, 0
    v_mov_b32 v255, 0
    buffer_atomic_add_x2 v[254:255], v253, s[52:55], s37 offen sc0 sc1
    s_mov_b64 exec, -1
Lp2_np:
    s_add_u32 s12, s6, 0x700000
    s_addc_u32 s13, s7, 0
    s_mov_b32 s14, 2883584
    s_mov_b32 s15, 0x00020000
    s_add_u32 s24, s6, 0xa00000
    s_addc_u32 s25, s7, 0
    s_mov_b32 s26, 2883584
    s_mov_b32 s27, 0x00020000
    s_cmp_lg_u32 s28, 2
    s_cbranch_scc1 Lp2_hb
Lp2_poll:
    s_waitcnt vmcnt(0)
    v_cmp_eq_u64 vcc, s[98:99], v[254:255]
    s_add_u32 s3, s3, 1
    s_nop 0
    s_andn2_b64 s[38:39], s[38:39], vcc
    s_cbranch_scc0 Lp2_hb
    s_sleep 2
    s_mov_b64 exec, s[38:39]
    v_mov_b32 v254, 0
    v_mov_b32 v255, 0
    buffer_atomic_add_x2 v[254:255], v253, s[52:55], s37 offen sc0 sc1
    s_mov_b64 exec, -1
    s_cmp_lt_u32 s3, 131072
    s_cbranch_scc1 Lp2_poll
Lp2_hb:
    s_mov_b32 m0, s44
    v_lshlrev_b32 v8, 4, v0
    s_waitcnt vmcnt(0)
    s_barrier
    buffer_load_dwordx4 v8, s[12:15], s43 offen offset:0 sc1 lds
    buffer_load_dwordx4 v8, s[12:15], s43 offen offset:1024 sc1 lds
    buffer_load_dwordx4 v8, s[12:15], s43 offen offset:2048 sc1 lds
    buffer_load_dwordx4 v8, s[12:15], s43 offen offset:3072 sc1 lds
    s_lshr_b32 s40, s28, 2
    s_lshl_b32 s33, s30, 4
    v_add_u32 v8, s33, v1
    v_sub_u32 v9, 256, v8
    s_cmp_lt_u32 s30, 6
    s_cselect_b64 vcc, -1, 0
    v_cndmask_b32 v8, v9, v8, vcc
    v_subrev_u32 v8, s47, v8
    v_lshlrev_b32 v4, 9, v2
    v_lshl_add_u32 v4, v8, 1, v4
    s_lshl_b32 s33, s40, 13
    s_add_u32 s33, s33, 131072
    v_add_u32 v4, s33, v4
    ds_read_u16_d16_hi v112, v4 offset:0
    ds_read_u16_d16_hi v128, v4 offset:16384
    ds_read_u16_d16_hi v113, v4 offset:128
    ds_read_u16_d16_hi v129, v4 offset:16512
    ds_read_u16_d16_hi v114, v4 offset:256
    ds_read_u16_d16_hi v130, v4 offset:16640
    ds_read_u16_d16_hi v115, v4 offset:384
    ds_read_u16_d16_hi v131, v4 offset:16768
    ds_read_u16_d16_hi v116, v4 offset:2048
    ds_read_u16_d16_hi v132, v4 offset:18432
    ds_read_u16_d16_hi v117, v4 offset:2176
    ds_read_u16_d16_hi v133, v4 offset:18560
    ds_read_u16_d16_hi v118, v4 offset:2304
    ds_read_u16_d16_hi v134, v4 offset:18688
    ds_read_u16_d16_hi v119, v4 offset:2432
    ds_read_u16_d16_hi v135, v4 offset:18816
    ds_read_u16_d16_hi v120, v4 offset:4096
    ds_read_u16_d16_hi v136, v4 offset:20480
    ds_read_u16_d16_hi v121, v4 offset:4224
    ds_read_u16_d16_hi v137, v4 offset:20608
    ds_read_u16_d16_hi v122, v4 offset:4352
    ds_read_u16_d16_hi v138, v4 offset:20736
    ds_read_u16_d16_hi v123, v4 offset:4480
    ds_read_u16_d16_hi v139, v4 offset:20864
    ds_read_u16_d16_hi v124, v4 offset:6144
    ds_read_u16_d16_hi v140, v4 offset:22528
    ds_read_u16_d16_hi v125, v4 offset:6272
    ds_read_u16_d16_hi v141, v4 offset:22656
    ds_read_u16_d16_hi v126, v4 offset:6400
    ds_read_u16_d16_hi v142, v4 offset:22784
    ds_read_u16_d16_hi v127, v4 offset:6528
    ds_read_u16_d16_hi v143, v4 offset:22912
    v_xor_b32 v80, 0x80008000, v48
    v_xor_b32 v81, 0x80008000, v49
    v_xor_b32 v82, 0x80008000, v50
    v_xor_b32 v83, 0x80008000, v51
    v_xor_b32 v84, 0x80008000, v52
    v_xor_b32 v85, 0x80008000, v53
    v_xor_b32 v86, 0x80008000, v54
    v_xor_b32 v87, 0x80008000, v55
    v_xor_b32 v88, 0x80008000, v56
    v_xor_b32 v89, 0x80008000, v57
    v_xor_b32 v90, 0x80008000, v58
    v_xor_b32 v91, 0x80008000, v59
    v_xor_b32 v92, 0x80008000, v60
    v_xor_b32 v93, 0x80008000, v61
    v_xor_b32 v94, 0x80008000, v62
    v_xor_b32 v95, 0x80008000, v63
    v_xor_b32 v96, 0x80008000, v64
    v_xor_b32 v97, 0x80008000, v65
    v_xor_b32 v98, 0x80008000, v66
    v_xor_b32 v99, 0x80008000, v67
    v_xor_b32 v100, 0x80008000, v68
    v_xor_b32 v101, 0x80008000, v69
    v_xor_b32 v102, 0x80008000, v70
    v_xor_b32 v103, 0x80008000, v71
    v_xor_b32 v104, 0x80008000, v72
    v_xor_b32 v105, 0x80008000, v73
    v_xor_b32 v106, 0x80008000, v74
    v_xor_b32 v107, 0x80008000, v75
    v_xor_b32 v108, 0x80008000, v76
    v_xor_b32 v109, 0x80008000, v77
    v_xor_b32 v110, 0x80008000, v78
    v_xor_b32 v111, 0x80008000, v79
    s_lshl_b32 s41, s40, 6
    s_add_u32 s33, s35, s41
    v_lshrrev_b32 v5, 2, v0
    v_lshlrev_b32 v5, 7, v5
    v_and_b32 v7, 3, v0
    v_lshl_add_u32 v5, v7, 4, v5
    v_add_u32 v5, s33, v5
    v_lshrrev_b32 v8, 3, v0
    s_mov_b32 s33, 45056
    v_mul_lo_u32 v6, v8, s33
    v_and_b32 v9, 7, v0
    v_lshl_add_u32 v6, v9, 4, v6
    s_lshl_b32 s36, s30, 12
    s_lshl_b32 s33, s29, 7
    s_add_u32 s36, s36, s33
    s_mul_i32 s33, s40, 1441792
    s_add_u32 s36, s36, s33
    s_add_u32 s33, s44, 65536
    v_xor_b32 v10, v8, v9
    v_lshl_add_u32 v3, v8, 7, s33
    v_lshl_add_u32 v3, v10, 4, v3
    s_add_u32 s33, s35, 65536
    v_xor_b32 v10, v2, v9
    v_lshl_add_u32 v7, v1, 7, s33
    v_lshl_add_u32 v7, v10, 4, v7
    v_xor_b32 v7, s41, v7
    s_waitcnt vmcnt(0) lgkmcnt(0)
    s_barrier
    v_mov_b32 v8, 131072
    v_mov_b32 v9, 0
    ds_write_b32 v8, v9
    s_lshl_b32 s33, s45, 2
    s_add_u32 s33, s33, s46
    s_cmp_lg_u32 s33, 11
    s_cbranch_scc1 Lp2_go
    s_waitcnt lgkmcnt(0)
    s_barrier
    s_branch Lp3
Lp2_go:
    ds_read_b64_tr_b16 v[144:145], v5 offset:0
    ds_read_b64_tr_b16 v[146:147], v5 offset:2048
    ds_read_b64_tr_b16 v[148:149], v5 offset:8
    ds_read_b64_tr_b16 v[150:151], v5 offset:2056
    ds_read_b64_tr_b16 v[152:153], v5 offset:4096
    ds_read_b64_tr_b16 v[154:155], v5 offset:6144
    ds_read_b64_tr_b16 v[156:157], v5 offset:4104
    ds_read_b64_tr_b16 v[158:159], v5 offset:6152
    s_waitcnt lgkmcnt(4)
    v_mfma_f32_16x16x32_bf16 v[176:179], v[16:19], v[144:147], 0
    v_mfma_f32_16x16x32_bf16 v[192:195], v[16:19], v[148:151], 0
    v_mfma_f32_16x16x32_bf16 v[176:179], v[48:51], v[148:151], v[176:179]
    v_mfma_f32_16x16x32_bf16 v[192:195], v[80:83], v[144:147], v[192:195]
    s_waitcnt lgkmcnt(0)
    v_mfma_f32_16x16x32_bf16 v[176:179], v[20:23], v[152:155], v[176:179]
    v_mfma_f32_16x16x32_bf16 v[192:195], v[20:23], v[156:159], v[192:195]
    v_mfma_f32_16x16x32_bf16 v[176:179], v[52:55], v[156:159], v[176:179]
    v_mfma_f32_16x16x32_bf16 v[192:195], v[84:87], v[152:155], v[192:195]
    v_mfma_f32_16x16x32_bf16 v[180:183], v[24:27], v[144:147], 0
    v_mfma_f32_16x16x32_bf16 v[196:199], v[24:27], v[148:151], 0
    v_mfma_f32_16x16x32_bf16 v[180:183], v[56:59], v[148:151], v[180:183]
    v_mfma_f32_16x16x32_bf16 v[196:199], v[88:91], v[144:147], v[196:199]
    v_mfma_f32_16x16x32_bf16 v[180:183], v[28:31], v[152:155], v[180:183]
    v_mfma_f32_16x16x32_bf16 v[196:199], v[28:31], v[156:159], v[196:199]
    v_mfma_f32_16x16x32_bf16 v[180:183], v[60:63], v[156:159], v[180:183]
    v_mfma_f32_16x16x32_bf16 v[196:199], v[92:95], v[152:155], v[196:199]
    v_mfma_f32_16x16x32_bf16 v[184:187], v[32:35], v[144:147], 0
    v_mul_f32 v8, v176, v112
    v_mul_f32 v12, v176, v128
    v_mfma_f32_16x16x32_bf16 v[200:203], v[32:35], v[148:151], 0
    v_mul_f32 v9, v177, v113
    v_mul_f32 v13, v177, v129
    v_mul_f32 v10, v178, v114
    v_mfma_f32_16x16x32_bf16 v[184:187], v[64:67], v[148:151], v[184:187]
    v_mul_f32 v14, v178, v130
    v_mul_f32 v11, v179, v115
    v_mfma_f32_16x16x32_bf16 v[200:203], v[96:99], v[144:147], v[200:203]
    v_mul_f32 v15, v179, v131
    v_fma_f32 v8, -v192, v128, v8
    v_fmac_f32 v12, v192, v112
    v_mfma_f32_16x16x32_bf16 v[184:187], v[36:39], v[152:155], v[184:187]
    v_fma_f32 v9, -v193, v129, v9
    v_fmac_f32 v13, v193, v113
    v_mfma_f32_16x16x32_bf16 v[200:203], v[36:39], v[156:159], v[200:203]
    v_fma_f32 v10, -v194, v130, v10
    v_fmac_f32 v14, v194, v114
    v_fma_f32 v11, -v195, v131, v11
    v_mfma_f32_16x16x32_bf16 v[184:187], v[68:71], v[156:159], v[184:187]
    v_fmac_f32 v15, v195, v115
    v_cvt_pk_bf16_f32 v160, v8, v9
    v_mfma_f32_16x16x32_bf16 v[200:203], v[100:103], v[152:155], v[200:203]
    v_cvt_pk_bf16_f32 v161, v10, v11
    v_cvt_pk_bf16_f32 v164, v12, v13
    v_cvt_pk_bf16_f32 v165, v14, v15
    v_mfma_f32_16x16x32_bf16 v[188:191], v[40:43], v[144:147], 0
    v_mul_f32 v8, v180, v116
    v_mul_f32 v12, v180, v132
    v_mfma_f32_16x16x32_bf16 v[204:207], v[40:43], v[148:151], 0
    v_mul_f32 v9, v181, v117
    v_mul_f32 v13, v181, v133
    v_mul_f32 v10, v182, v118
    v_mfma_f32_16x16x32_bf16 v[188:191], v[72:75], v[148:151], v[188:191]
    v_mul_f32 v14, v182, v134
    v_mul_f32 v11, v183, v119
    v_mfma_f32_16x16x32_bf16 v[204:207], v[104:107], v[144:147], v[204:207]
    v_mul_f32 v15, v183, v135
    v_fma_f32 v8, -v196, v132, v8
    v_fmac_f32 v12, v196, v116
    v_mfma_f32_16x16x32_bf16 v[188:191], v[44:47], v[152:155], v[188:191]
    v_fma_f32 v9, -v197, v133, v9
    v_fmac_f32 v13, v197, v117
    v_mfma_f32_16x16x32_bf16 v[204:207], v[44:47], v[156:159], v[204:207]
    v_fma_f32 v10, -v198, v134, v10
    v_fmac_f32 v14, v198, v118
    v_fma_f32 v11, -v199, v135, v11
    v_mfma_f32_16x16x32_bf16 v[188:191], v[76:79], v[156:159], v[188:191]
    v_fmac_f32 v15, v199, v119
    v_cvt_pk_bf16_f32 v162, v8, v9
    v_mfma_f32_16x16x32_bf16 v[204:207], v[108:111], v[152:155], v[204:207]
    v_cvt_pk_bf16_f32 v163, v10, v11
    v_cvt_pk_bf16_f32 v166, v12, v13
    v_cvt_pk_bf16_f32 v167, v14, v15
    v_mfma_f32_16x16x32_bf16 v[208:211], v[160:163], v[16:19], 0
    v_mul_f32 v8, v184, v120
    v_mul_f32 v12, v184, v136
    v_mfma_f32_16x16x32_bf16 v[224:227], v[164:167], v[16:19], 0
    v_mul_f32 v9, v185, v121
    v_mul_f32 v13, v185, v137
    v_mul_f32 v10, v186, v122
    v_mfma_f32_16x16x32_bf16 v[208:211], v[164:167], v[80:83], v[208:211]
    v_mul_f32 v14, v186, v138
    v_mul_f32 v11, v187, v123
    v_mfma_f32_16x16x32_bf16 v[224:227], v[160:163], v[48:51], v[224:227]
    v_mul_f32 v15, v187, v139
    v_fma_f32 v8, -v200, v136, v8
    v_fmac_f32 v12, v200, v120
    v_mfma_f32_16x16x32_bf16 v[212:215], v[160:163], v[24:27], 0
    v_fma_f32 v9, -v201, v137, v9
    v_fmac_f32 v13, v201, v121
    v_mfma_f32_16x16x32_bf16 v[228:231], v[164:167], v[24:27], 0
    v_fma_f32 v10, -v202, v138, v10
    v_fmac_f32 v14, v202, v122
    v_fma_f32 v11, -v203, v139, v11
    v_mfma_f32_16x16x32_bf16 v[212:215], v[164:167], v[88:91], v[212:215]
    v_fmac_f32 v15, v203, v123
    v_cvt_pk_bf16_f32 v168, v8, v9
    v_mfma_f32_16x16x32_bf16 v[228:231], v[160:163], v[56:59], v[228:231]
    v_cvt_pk_bf16_f32 v169, v10, v11
    v_cvt_pk_bf16_f32 v172, v12, v13
    v_cvt_pk_bf16_f32 v173, v14, v15
    v_mfma_f32_16x16x32_bf16 v[216:219], v[160:163], v[32:35], 0
    v_mul_f32 v8, v188, v124
    v_mul_f32 v12, v188, v140
    v_mfma_f32_16x16x32_bf16 v[232:235], v[164:167], v[32:35], 0
    v_mul_f32 v9, v189, v125
    v_mul_f32 v13, v189, v141
    v_mul_f32 v10, v190, v126
    v_mfma_f32_16x16x32_bf16 v[216:219], v[164:167], v[96:99], v[216:219]
    v_mul_f32 v14, v190, v142
    v_mul_f32 v11, v191, v127
    v_mfma_f32_16x16x32_bf16 v[232:235], v[160:163], v[64:67], v[232:235]
    v_mul_f32 v15, v191, v143
    v_fma_f32 v8, -v204, v140, v8
    v_fmac_f32 v12, v204, v124
    v_mfma_f32_16x16x32_bf16 v[220:223], v[160:163], v[40:43], 0
    v_fma_f32 v9, -v205, v141, v9
    v_fmac_f32 v13, v205, v125
    v_mfma_f32_16x16x32_bf16 v[236:239], v[164:167], v[40:43], 0
    v_fma_f32 v10, -v206, v142, v10
    v_fmac_f32 v14, v206, v126
    v_fma_f32 v11, -v207, v143, v11
    v_mfma_f32_16x16x32_bf16 v[220:223], v[164:167], v[104:107], v[220:223]
    v_fmac_f32 v15, v207, v127
    v_cvt_pk_bf16_f32 v170, v8, v9
    v_mfma_f32_16x16x32_bf16 v[236:239], v[160:163], v[72:75], v[236:239]
    v_cvt_pk_bf16_f32 v171, v10, v11
    v_cvt_pk_bf16_f32 v174, v12, v13
    v_cvt_pk_bf16_f32 v175, v14, v15
    v_mfma_f32_16x16x32_bf16 v[208:211], v[168:171], v[20:23], v[208:211]
    s_nop 0
    v_mfma_f32_16x16x32_bf16 v[224:227], v[172:175], v[20:23], v[224:227]
    v_mfma_f32_16x16x32_bf16 v[208:211], v[172:175], v[84:87], v[208:211]
    v_mfma_f32_16x16x32_bf16 v[224:227], v[168:171], v[52:55], v[224:227]
    v_mfma_f32_16x16x32_bf16 v[212:215], v[168:171], v[28:31], v[212:215]
    v_mfma_f32_16x16x32_bf16 v[228:231], v[172:175], v[28:31], v[228:231]
    v_mfma_f32_16x16x32_bf16 v[212:215], v[172:175], v[92:95], v[212:215]
    v_mfma_f32_16x16x32_bf16 v[228:231], v[168:171], v[60:63], v[228:231]
    v_mfma_f32_16x16x32_bf16 v[216:219], v[168:171], v[36:39], v[216:219]
    s_nop 1
    v_cvt_pk_bf16_f32 v112, v208, v209
    v_mfma_f32_16x16x32_bf16 v[232:235], v[172:175], v[36:39], v[232:235]
    v_cvt_pk_bf16_f32 v113, v210, v211
    v_mfma_f32_16x16x32_bf16 v[216:219], v[172:175], v[100:103], v[216:219]
    v_cvt_pk_bf16_f32 v114, v224, v225
    v_mfma_f32_16x16x32_bf16 v[232:235], v[168:171], v[68:71], v[232:235]
    v_cvt_pk_bf16_f32 v115, v226, v227
    ds_write_b128 v7, v[112:115] offset:0
    v_mfma_f32_16x16x32_bf16 v[220:223], v[168:171], v[44:47], v[220:223]
    v_cvt_pk_bf16_f32 v116, v212, v213
    v_mfma_f32_16x16x32_bf16 v[236:239], v[172:175], v[44:47], v[236:239]
    v_cvt_pk_bf16_f32 v117, v214, v215
    v_mfma_f32_16x16x32_bf16 v[220:223], v[172:175], v[108:111], v[220:223]
    v_cvt_pk_bf16_f32 v118, v228, v229
    v_mfma_f32_16x16x32_bf16 v[236:239], v[168:171], v[76:79], v[236:239]
    v_cvt_pk_bf16_f32 v119, v230, v231
    ds_write_b128 v7, v[116:119] offset:2048
    v_cvt_pk_bf16_f32 v120, v216, v217
    v_cvt_pk_bf16_f32 v121, v218, v219
    v_cvt_pk_bf16_f32 v122, v232, v233
    v_cvt_pk_bf16_f32 v123, v234, v235
    ds_write_b128 v7, v[120:123] offset:4096
    v_cvt_pk_bf16_f32 v124, v220, v221
    v_cvt_pk_bf16_f32 v125, v222, v223
    v_cvt_pk_bf16_f32 v126, v236, v237
    v_cvt_pk_bf16_f32 v127, v238, v239
    ds_write_b128 v7, v[124:127] offset:6144
    s_waitcnt lgkmcnt(0)
    s_barrier
    ds_read_b128 v[128:131], v3 offset:0
    ds_read_b128 v[132:135], v3 offset:1024
    ds_read_b128 v[136:139], v3 offset:2048
    ds_read_b128 v[140:143], v3 offset:3072
    s_add_u32 s37, s36, 0
    s_waitcnt lgkmcnt(3)
    buffer_store_dwordx4 v[128:131], v6, s[24:27], s37 offen sc1
    s_add_u32 s37, s36, 360448
    s_waitcnt lgkmcnt(2)
    buffer_store_dwordx4 v[132:135], v6, s[24:27], s37 offen sc1
    s_add_u32 s37, s36, 720896
    s_waitcnt lgkmcnt(1)
    buffer_store_dwordx4 v[136:139], v6, s[24:27], s37 offen sc1
    s_add_u32 s37, s36, 1081344
    s_waitcnt lgkmcnt(0)
    buffer_store_dwordx4 v[140:143], v6, s[24:27], s37 offen sc1
Lp3:
    s_load_dwordx2 s[8:9], s[0:1], 64
    s_mul_i32 s48, s29, 10
    s_lshr_b32 s40, s32, 2
    s_lshl_b32 s40, s40, 1
    s_add_u32 s48, s48, s40
    s_and_b32 s40, s31, 1
    s_add_u32 s48, s48, s40
    s_lshl_b32 s48, s48, 7
    s_add_u32 s48, s48, 135168
    s_lshl_b32 s29, s31, 3
    s_lshr_b32 s33, s32, 2
    s_add_u32 s29, s29, s33
    s_and_b32 s30, s32, 1
    v_lshlrev_b32 v3, 4, v0
    v_and_b32 v1, 15, v0
    v_lshrrev_b32 v2, 4, v0
    v_cvt_f32_u32 v7, v2
    v_mul_f32 v7, 4.0, v7
    s_lshl_b32 s33, s32, 3
    s_add_u32 s33, s33, s28
    s_cmp_lg_u32 s33, 6
    s_cbranch_scc1 Lp3_nc
    s_getpc_b64 s[36:37]
Lcpf3:
    s_add_u32 s36, s36, Lp3-Lcpf3
    s_addc_u32 s37, s37, (Lp3-Lcpf3)>>32
    v_lshlrev_b32 v14, 7, v0
    v_min_u32 v14, Lk1_end-Lp3, v14
    v_mov_b32 v15, s37
    v_add_co_u32 v14, vcc, s36, v14
    s_nop 1
    v_addc_co_u32 v15, vcc, 0, v15, vcc
    global_load_dword v16, v[14:15], off
Lp3_nc:
    s_bfe_u32 s33, s32, 0x10001
    s_mul_i32 s33, s33, 5
    s_add_u32 s42, s33, 7
    s_sub_u32 s42, s42, s28
    s_lshl_b32 s33, s30, 10
    s_add_u32 s33, s33, s29
    v_lshl_add_u32 v6, v2, 8, s33
    v_mul_u32_u24 v6, 1280, v6
    v_lshl_add_u32 v6, v1, 3, v6
    s_lshl_b32 s44, s42, 7
    s_add_u32 s45, s44, 81920
    s_add_u32 s46, s45, 81920
    s_add_u32 s47, s46, 81920
    v_lshlrev_b32 v252, 5, v0
    v_lshlrev_b32 v253, 7, v0
    s_mul_i32 s50, s29, 10
    s_add_u32 s50, s50, s42
    s_lshl_b32 s50, s50, 12
    s_lshl_b32 s34, s30, 11
    s_add_u32 s50, s50, s34
    s_add_u32 s49, s50, 2621440
    s_lshr_b32 s43, s29, 2
    s_mul_i32 s43, s43, 10
    s_and_b32 s34, s42, 14
    s_add_u32 s43, s43, s34
    s_lshl_b32 s43, s43, 7
    s_add_u32 s43, s43, 135168
    s_cmp_ge_u32 s28, 6
    s_cbranch_scc1 Lp3_nfa
    s_lshl_b32 s33, s30, 10
    s_add_u32 s33, s33, s29
    v_lshl_add_u32 v5, v1, 6, s33
    v_cvt_f32_u32 v5, v5
    v_mul_f32 v5, 0x3a000000, v5
    v_mul_f32 v15, v7, v5
    v_fmamk_f32 v8, v5, 0x00000000, v15
    v_fmamk_f32 v9, v5, 0x3f800000, v15
    v_cos_f32 v10, v8
    v_cos_f32 v11, v9
    v_sin_f32 v12, v8
    v_sin_f32 v13, v9
    v_cvt_pk_bf16_f32 v16, v10, v11
    v_cvt_pk_bf16_f32 v20, v12, v13
    v_cvt_pk_bf16_f32 v24, -v12, -v13
    v_fmamk_f32 v8, v5, 0x40000000, v15
    v_fmamk_f32 v9, v5, 0x40400000, v15
    v_cos_f32 v10, v8
    v_cos_f32 v11, v9
    v_sin_f32 v12, v8
    v_sin_f32 v13, v9
    v_cvt_pk_bf16_f32 v17, v10, v11
    v_cvt_pk_bf16_f32 v21, v12, v13
    v_cvt_pk_bf16_f32 v25, -v12, -v13
    v_fmamk_f32 v8, v5, 0x41800000, v15
    v_fmamk_f32 v9, v5, 0x41880000, v15
    v_cos_f32 v10, v8
    v_cos_f32 v11, v9
    v_sin_f32 v12, v8
    v_sin_f32 v13, v9
    v_cvt_pk_bf16_f32 v18, v10, v11
    v_cvt_pk_bf16_f32 v22, v12, v13
    v_cvt_pk_bf16_f32 v26, -v12, -v13
    v_fmamk_f32 v8, v5, 0x41900000, v15
    v_fmamk_f32 v9, v5, 0x41980000, v15
    v_cos_f32 v10, v8
    v_cos_f32 v11, v9
    v_sin_f32 v12, v8
    v_sin_f32 v13, v9
    v_cvt_pk_bf16_f32 v19, v10, v11
    v_cvt_pk_bf16_f32 v23, v12, v13
    v_cvt_pk_bf16_f32 v27, -v12, -v13
    s_lshl_b32 s33, s28, 4
    v_cvt_f32_u32 v8, s33
    v_add_f32 v8, v8, v7
    v_add_f32 v9, 0x00000000, v8
    v_mul_f32 v10, 0x3acccccd, v9
    v_cos_f32 v28, v10
    v_sin_f32 v32, v10
    v_mul_f32 v10, 0x3b4ccccd, v9
    v_cos_f32 v36, v10
    v_sin_f32 v40, v10
    v_mul_f32 v10, 0x3b99999a, v9
    v_cos_f32 v44, v10
    v_sin_f32 v48, v10
    v_add_f32 v9, 0x3f800000, v8
    v_mul_f32 v10, 0x3acccccd, v9
    v_cos_f32 v29, v10
    v_sin_f32 v33, v10
    v_mul_f32 v10, 0x3b4ccccd, v9
    v_cos_f32 v37, v10
    v_sin_f32 v41, v10
    v_mul_f32 v10, 0x3b99999a, v9
    v_cos_f32 v45, v10
    v_sin_f32 v49, v10
    v_add_f32 v9, 0x40000000, v8
    v_mul_f32 v10, 0x3acccccd, v9
    v_cos_f32 v30, v10
    v_sin_f32 v34, v10
    v_mul_f32 v10, 0x3b4ccccd, v9
    v_cos_f32 v38, v10
    v_sin_f32 v42, v10
    v_mul_f32 v10, 0x3b99999a, v9
    v_cos_f32 v46, v10
    v_sin_f32 v50, v10
    v_add_f32 v9, 0x40400000, v8
    v_mul_f32 v10, 0x3acccccd, v9
    v_cos_f32 v31, v10
    v_sin_f32 v35, v10
    v_mul_f32 v10, 0x3b4ccccd, v9
    v_cos_f32 v39, v10
    v_sin_f32 v43, v10
    v_mul_f32 v10, 0x3b99999a, v9
    v_cos_f32 v47, v10
    v_sin_f32 v51, v10
Lp3_nfa:
    v_mov_b32 v8, 131072
    v_mov_b32 v9, 1
    v_mov_b32 v248, s98
    v_mov_b32 v249, s99
    v_mov_b32 v250, s98
    v_mov_b32 v251, s99
    v_lshlrev_b32 v11, 10, v0
    s_waitcnt vmcnt(0)
    s_mov_b64 exec, 1
    ds_add_rtn_u32 v10, v8, v9
    s_mov_b64 exec, -1
    s_waitcnt lgkmcnt(0)
    v_readfirstlane_b32 s33, v10
    s_nop 0
    s_cmp_lg_u32 s33, 7
    s_cbranch_scc1 Lp3_np
    s_cmp_ge_u32 s32, 20
    s_cbranch_scc1 Lp3_pu
    s_mov_b64 exec, 0xff
    buffer_store_dwordx4 v[248:251], v3, s[52:55], s48 offen sc1
    s_mov_b64 exec, -1
    s_branch Lp3_np
Lp3_pu:
    s_lshl_b32 s33, s31, 7
    s_add_u32 s34, s33, 102400
    s_mov_b32 exec_hi, 0
    buffer_atomic_add v9, v11, s[52:55], s34 offen sc1
    s_mov_b64 exec, -1
Lp3_np:
    s_add_u32 s12, s6, 0xa00000
    s_addc_u32 s13, s7, 0
    s_mov_b32 s14, 2883584
    s_mov_b32 s15, 0x00020000
    s_add_u32 s20, s6, 0xd00000
    s_addc_u32 s21, s7, 0
    s_mov_b32 s22, 5242880
    s_mov_b32 s23, 0x00020000
    s_mov_b32 s16, s4
    s_mov_b32 s17, s5
    s_mov_b32 s18, 2621440
    s_mov_b32 s19, 0x00020000
    s_mov_b32 s24, s8
    s_mov_b32 s25, s9
    s_mov_b32 s26, 2621440
    s_mov_b32 s27, 0x00020000
    s_cmp_lt_u32 s28, 4
    s_cbranch_scc1 Lp3_nb1
    s_lshl_b32 s37, s32, 10
    s_add_u32 s37, s37, 102400
    s_mov_b32 s3, 0
    s_movk_i32 s38, 0xff
    s_mov_b32 s39, 0
    s_cmp_lg_u32 s28, 7
    s_cbranch_scc1 Lp3_u0
    s_mov_b64 exec, s[38:39]
    v_mov_b32 v254, 0
    v_mov_b32 v255, 0
    buffer_atomic_add_x2 v[254:255], v253, s[52:55], s37 offen sc0 sc1
    s_mov_b64 exec, -1
Lp3_u0:
    buffer_load_dwordx2 v[240:241], v6, s[16:19], s44 offen
    buffer_load_dwordx2 v[242:243], v6, s[16:19], s45 offen
    buffer_load_dwordx2 v[244:245], v6, s[16:19], s46 offen
    buffer_load_dwordx2 v[246:247], v6, s[16:19], s47 offen
    s_lshl_b32 s33, s42, 4
    v_add_u32 v14, s33, v1
    v_cvt_f32_u32 v15, v14
    v_mul_f32 v15, 0x3bcccccd, v15
    v_mul_f32 v4, v7, v15
    v_fmamk_f32 v8, v15, 0x00000000, v4
    v_fmamk_f32 v9, v15, 0x3f800000, v4
    v_cos_f32 v10, v8
    v_cos_f32 v11, v9
    v_sin_f32 v12, v8
    v_sin_f32 v13, v9
    v_cmp_gt_u32 vcc, 16, v0
    v_mov_b32 v8, 0.5
    s_nop 0
    v_cndmask_b32 v10, v10, v8, vcc
    v_cvt_pk_bf16_f32 v52, v10, v11
    v_cvt_pk_bf16_f32 v54, -v12, -v13
    v_fmamk_f32 v8, v15, 0x40000000, v4
    v_fmamk_f32 v9, v15, 0x40400000, v4
    v_cos_f32 v10, v8
    v_cos_f32 v11, v9
    v_sin_f32 v12, v8
    v_sin_f32 v13, v9
    v_cvt_pk_bf16_f32 v53, v10, v11
    v_cvt_pk_bf16_f32 v55, -v12, -v13
    v_fmamk_f32 v8, v15, 0x41800000, v4
    v_fmamk_f32 v9, v15, 0x41880000, v4
    v_cos_f32 v10, v8
    v_cos_f32 v11, v9
    v_sin_f32 v12, v8
    v_sin_f32 v13, v9
    v_cvt_pk_bf16_f32 v56, v10, v11
    v_cvt_pk_bf16_f32 v58, -v12, -v13
    v_fmamk_f32 v8, v15, 0x41900000, v4
    v_fmamk_f32 v9, v15, 0x41980000, v4
    v_cos_f32 v10, v8
    v_cos_f32 v11, v9
    v_sin_f32 v12, v8
    v_sin_f32 v13, v9
    v_cvt_pk_bf16_f32 v57, v10, v11
    v_cvt_pk_bf16_f32 v59, -v12, -v13
    v_fmamk_f32 v8, v15, 0x42000000, v4
    v_fmamk_f32 v9, v15, 0x42040000, v4
    v_cos_f32 v10, v8
    v_cos_f32 v11, v9
    v_sin_f32 v12, v8
    v_sin_f32 v13, v9
    v_cvt_pk_bf16_f32 v60, v10, v11
    v_cvt_pk_bf16_f32 v62, -v12, -v13
    v_fmamk_f32 v8, v15, 0x42080000, v4
    v_fmamk_f32 v9, v15, 0x420c0000, v4
    v_cos_f32 v10, v8
    v_cos_f32 v11, v9
    v_sin_f32 v12, v8
    v_sin_f32 v13, v9
    v_cvt_pk_bf16_f32 v61, v10, v11
    v_cvt_pk_bf16_f32 v63, -v12, -v13
    v_fmamk_f32 v8, v15, 0x42400000, v4
    v_fmamk_f32 v9, v15, 0x42440000, v4
    v_cos_f32 v10, v8
    v_cos_f32 v11, v9
    v_sin_f32 v12, v8
    v_sin_f32 v13, v9
    v_cvt_pk_bf16_f32 v64, v10, v11
    v_cvt_pk_bf16_f32 v66, -v12, -v13
    v_fmamk_f32 v8, v15, 0x42480000, v4
    v_fmamk_f32 v9, v15, 0x424c0000, v4
    v_cos_f32 v10, v8
    v_cos_f32 v11, v9
    v_sin_f32 v12, v8
    v_sin_f32 v13, v9
    v_cvt_pk_bf16_f32 v65, v10, v11
    v_cvt_pk_bf16_f32 v67, -v12, -v13
    v_fmamk_f32 v8, v15, 0x42800000, v4
    v_fmamk_f32 v9, v15, 0x42820000, v4
    v_cos_f32 v10, v8
    v_cos_f32 v11, v9
    v_sin_f32 v12, v8
    v_sin_f32 v13, v9
    v_cvt_pk_bf16_f32 v68, v10, v11
    v_cvt_pk_bf16_f32 v70, -v12, -v13
    v_fmamk_f32 v8, v15, 0x42840000, v4
    v_fmamk_f32 v9, v15, 0x42860000, v4
    v_cos_f32 v10, v8
    v_cos_f32 v11, v9
    v_sin_f32 v12, v8
    v_sin_f32 v13, v9
    v_cvt_pk_bf16_f32 v69, v10, v11
    v_cvt_pk_bf16_f32 v71, -v12, -v13
    v_and_b32 v8, 1, v14
    v_lshlrev_b32 v8, 15, v8
    v_or_b32 v8, 0x3f80, v8
    v_cndmask_b32 v72, 0, v8, vcc
    v_mov_b32 v73, 0
    v_mov_b32 v74, 0
    v_mov_b32 v75, 0
    s_cmp_lg_u32 s28, 7
    s_cbranch_scc1 Lp3_nb1
Lp3_up:
    s_waitcnt vmcnt(0)
    v_cmp_eq_u32 vcc, 12, v254
    s_add_u32 s3, s3, 1
    s_nop 0
    s_andn2_b64 s[38:39], s[38:39], vcc
    s_cbranch_scc0 Lp3_nb1
    s_sleep 2
    s_mov_b64 exec, s[38:39]
    v_mov_b32 v254, 0
    v_mov_b32 v255, 0
    buffer_atomic_add_x2 v[254:255], v253, s[52:55], s37 offen sc0 sc1
    s_mov_b64 exec, -1
    s_cmp_lt_u32 s3, 131072
    s_cbranch_scc1 Lp3_up
Lp3_nb1:
    s_mul_i32 s33, s29, 45056
    s_lshl_b32 s34, s28, 12
    s_add_u32 s33, s33, s34
    s_add_u32 s34, s33, 24576
    s_lshl_b32 s35, s28, 13
    s_mov_b32 m0, s35
    s_cmp_eq_u32 s28, 5
    s_cselect_b32 s36, 0x80000000, 0
    v_or_b32 v4, s36, v3
    s_mov_b64 s[38:39], 3
    s_mov_b32 s40, 0
    s_barrier
    s_cmp_ge_u32 s28, 6
    s_cbranch_scc1 Lp3_nf2
    buffer_load_dwordx4 v3, s[12:15], s33 offen offset:0 sc1 lds
    buffer_load_dwordx4 v3, s[12:15], s33 offen offset:1024 sc1 lds
    buffer_load_dwordx4 v3, s[12:15], s33 offen offset:2048 sc1 lds
    buffer_load_dwordx4 v3, s[12:15], s33 offen offset:3072 sc1 lds
    s_add_u32 m0, s35, 4096
    s_nop 0
    buffer_load_dwordx4 v4, s[12:15], s34 offen offset:0 sc1 lds
    buffer_load_dwordx4 v4, s[12:15], s34 offen offset:1024 sc1 lds
    buffer_load_dwordx4 v4, s[12:15], s34 offen offset:2048 sc1 lds
    buffer_load_dwordx4 v4, s[12:15], s34 offen offset:3072 sc1 lds
Lp3_nf2:
    s_cmp_lg_u32 s28, 3
    s_cbranch_scc1 Lp3_n2b
    buffer_load_dwordx2 v[240:241], v6, s[16:19], s44 offen
    buffer_load_dwordx2 v[242:243], v6, s[16:19], s45 offen
    buffer_load_dwordx2 v[244:245], v6, s[16:19], s46 offen
    buffer_load_dwordx2 v[246:247], v6, s[16:19], s47 offen
    s_lshl_b32 s33, s42, 4
    v_add_u32 v14, s33, v1
    v_cvt_f32_u32 v15, v14
    v_mul_f32 v15, 0x3bcccccd, v15
    v_mul_f32 v4, v7, v15
    v_fmamk_f32 v8, v15, 0x00000000, v4
    v_fmamk_f32 v9, v15, 0x3f800000, v4
    v_cos_f32 v10, v8
    v_cos_f32 v11, v9
    v_sin_f32 v12, v8
    v_sin_f32 v13, v9
    v_cmp_gt_u32 vcc, 16, v0
    v_mov_b32 v8, 0.5
    s_nop 0
    v_cndmask_b32 v10, v10, v8, vcc
    v_cvt_pk_bf16_f32 v52, v10, v11
    v_cvt_pk_bf16_f32 v54, -v12, -v13
    v_fmamk_f32 v8, v15, 0x40000000, v4
    v_fmamk_f32 v9, v15, 0x40400000, v4
    v_cos_f32 v10, v8
    v_cos_f32 v11, v9
    v_sin_f32 v12, v8
    v_sin_f32 v13, v9
    v_cvt_pk_bf16_f32 v53, v10, v11
    v_cvt_pk_bf16_f32 v55, -v12, -v13
    v_fmamk_f32 v8, v15, 0x41800000, v4
    v_fmamk_f32 v9, v15, 0x41880000, v4
    v_cos_f32 v10, v8
    v_cos_f32 v11, v9
    v_sin_f32 v12, v8
    v_sin_f32 v13, v9
    v_cvt_pk_bf16_f32 v56, v10, v11
    v_cvt_pk_bf16_f32 v58, -v12, -v13
    v_fmamk_f32 v8, v15, 0x41900000, v4
    v_fmamk_f32 v9, v15, 0x41980000, v4
    v_cos_f32 v10, v8
    v_cos_f32 v11, v9
    v_sin_f32 v12, v8
    v_sin_f32 v13, v9
    v_cvt_pk_bf16_f32 v57, v10, v11
    v_cvt_pk_bf16_f32 v59, -v12, -v13
    v_fmamk_f32 v8, v15, 0x42000000, v4
    v_fmamk_f32 v9, v15, 0x42040000, v4
    v_cos_f32 v10, v8
    v_cos_f32 v11, v9
    v_sin_f32 v12, v8
    v_sin_f32 v13, v9
    v_cvt_pk_bf16_f32 v60, v10, v11
    v_cvt_pk_bf16_f32 v62, -v12, -v13
    v_fmamk_f32 v8, v15, 0x42080000, v4
    v_fmamk_f32 v9, v15, 0x420c0000, v4
    v_cos_f32 v10, v8
    v_cos_f32 v11, v9
    v_sin_f32 v12, v8
    v_sin_f32 v13, v9
    v_cvt_pk_bf16_f32 v61, v10, v11
    v_cvt_pk_bf16_f32 v63, -v12, -v13
    v_fmamk_f32 v8, v15, 0x42400000, v4
    v_fmamk_f32 v9, v15, 0x42440000, v4
    v_cos_f32 v10, v8
    v_cos_f32 v11, v9
    v_sin_f32 v12, v8
    v_sin_f32 v13, v9
    v_cvt_pk_bf16_f32 v64, v10, v11
    v_cvt_pk_bf16_f32 v66, -v12, -v13
    v_fmamk_f32 v8, v15, 0x42480000, v4
    v_fmamk_f32 v9, v15, 0x424c0000, v4
    v_cos_f32 v10, v8
    v_cos_f32 v11, v9
    v_sin_f32 v12, v8
    v_sin_f32 v13, v9
    v_cvt_pk_bf16_f32 v65, v10, v11
    v_cvt_pk_bf16_f32 v67, -v12, -v13
    v_fmamk_f32 v8, v15, 0x42800000, v4
    v_fmamk_f32 v9, v15, 0x42820000, v4
    v_cos_f32 v10, v8
    v_cos_f32 v11, v9
    v_sin_f32 v12, v8
    v_sin_f32 v13, v9
    v_cvt_pk_bf16_f32 v68, v10, v11
    v_cvt_pk_bf16_f32 v70, -v12, -v13
    v_fmamk_f32 v8, v15, 0x42840000, v4
    v_fmamk_f32 v9, v15, 0x42860000, v4
    v_cos_f32 v10, v8
    v_cos_f32 v11, v9
    v_sin_f32 v12, v8
    v_sin_f32 v13, v9
    v_cvt_pk_bf16_f32 v69, v10, v11
    v_cvt_pk_bf16_f32 v71, -v12, -v13
    v_and_b32 v8, 1, v14
    v_lshlrev_b32 v8, 15, v8
    v_or_b32 v8, 0x3f80, v8
    v_cndmask_b32 v72, 0, v8, vcc
    v_mov_b32 v73, 0
    v_mov_b32 v74, 0
    v_mov_b32 v75, 0
Lp3_n2b:
    s_cmp_lt_u32 s28, 3
    s_cbranch_scc1 Lp3_n3
    s_mov_b64 exec, 3
    v_mov_b32 v254, 0
    v_mov_b32 v255, 0
    buffer_atomic_add_x2 v[254:255], v253, s[52:55], s43 offen sc0 sc1
    s_mov_b64 exec, -1
Lp3_n3:
    s_cmp_ge_u32 s28, 6
    s_cbranch_scc1 Lp3_nf3
    v_lshrrev_b32 v5, 2, v0
    v_lshlrev_b32 v5, 7, v5
    v_and_b32 v8, 3, v0
    v_lshl_add_u32 v5, v8, 4, v5
    v_add_u32 v5, s35, v5
    s_lshl_b32 s33, s28, 12
    s_add_u32 s33, s33, 49152
    v_add_u32 v14, s33, v3
    s_cmp_lt_u32 s28, 3
    s_cbranch_scc0 Lp3_w1
    s_waitcnt vmcnt(0)
Lp3_w1:
    s_waitcnt vmcnt(1)
    ds_read_b64_tr_b16 v[144:145], v5 offset:0
    ds_read_b64_tr_b16 v[146:147], v5 offset:2048
    ds_read_b64_tr_b16 v[148:149], v5 offset:8
    ds_read_b64_tr_b16 v[150:151], v5 offset:2056
    ds_read_b64_tr_b16 v[168:169], v5 offset:4160
    ds_read_b64_tr_b16 v[170:171], v5 offset:6208
    ds_read_b64_tr_b16 v[172:173], v5 offset:4168
    ds_read_b64_tr_b16 v[174:175], v5 offset:6216
    ds_read_b64_tr_b16 v[152:153], v5 offset:64
    ds_read_b64_tr_b16 v[154:155], v5 offset:2112
    ds_read_b64_tr_b16 v[156:157], v5 offset:72
    ds_read_b64_tr_b16 v[158:159], v5 offset:2120
    ds_read_b64_tr_b16 v[160:161], v5 offset:4096
    ds_read_b64_tr_b16 v[162:163], v5 offset:6144
    ds_read_b64_tr_b16 v[164:165], v5 offset:4104
    ds_read_b64_tr_b16 v[166:167], v5 offset:6152
    s_waitcnt lgkmcnt(12)
    v_mfma_f32_16x16x32_bf16 v[176:179], v[144:147], v[16:19], 0
    v_mfma_f32_16x16x32_bf16 v[180:183], v[148:151], v[16:19], 0
    v_mfma_f32_16x16x32_bf16 v[176:179], v[148:151], v[24:27], v[176:179]
    v_mfma_f32_16x16x32_bf16 v[180:183], v[144:147], v[20:23], v[180:183]
    s_waitcnt lgkmcnt(8)
    v_mfma_f32_16x16x32_bf16 v[200:203], v[168:171], v[16:19], 0
    v_mfma_f32_16x16x32_bf16 v[204:207], v[172:175], v[16:19], 0
    v_mfma_f32_16x16x32_bf16 v[200:203], v[172:175], v[24:27], v[200:203]
    v_mfma_f32_16x16x32_bf16 v[204:207], v[168:171], v[20:23], v[204:207]
    s_waitcnt lgkmcnt(4)
    v_mfma_f32_16x16x32_bf16 v[184:187], v[152:155], v[16:19], 0
    v_mfma_f32_16x16x32_bf16 v[188:191], v[156:159], v[16:19], 0
    v_mfma_f32_16x16x32_bf16 v[184:187], v[156:159], v[24:27], v[184:187]
    v_mfma_f32_16x16x32_bf16 v[188:191], v[152:155], v[20:23], v[188:191]
    s_waitcnt lgkmcnt(0)
    v_mfma_f32_16x16x32_bf16 v[192:195], v[160:163], v[16:19], 0
    v_mfma_f32_16x16x32_bf16 v[196:199], v[164:167], v[16:19], 0
    v_mfma_f32_16x16x32_bf16 v[192:195], v[164:167], v[24:27], v[192:195]
    v_mfma_f32_16x16x32_bf16 v[196:199], v[160:163], v[20:23], v[196:199]
    s_cmp_lt_u32 s28, 3
    s_cbranch_scc1 Lps1
    s_cmp_lg_u32 s40, 0
    s_cbranch_scc1 Lps1
    s_mov_b32 s3, 0
Lpr1:
    s_waitcnt vmcnt(0)
    v_cmp_eq_u64 vcc, s[98:99], v[254:255]
    s_add_u32 s3, s3, 1
    s_nop 0
    s_andn2_b64 s[38:39], s[38:39], vcc
    s_cbranch_scc0 Lpo1
    s_mov_b64 exec, s[38:39]
    v_mov_b32 v254, 0
    v_mov_b32 v255, 0
    buffer_atomic_add_x2 v[254:255], v253, s[52:55], s43 offen sc0 sc1
    s_mov_b64 exec, -1
    s_branch Lps1
Lpo1:
    s_mov_b32 s40, 1
    buffer_load_dwordx4 v[76:79], v252, s[20:23], s50 offen offset:0 sc1
    buffer_load_dwordx4 v[84:87], v252, s[20:23], s49 offen offset:0 sc1
    buffer_load_dwordx4 v[80:83], v252, s[20:23], s50 offen offset:16 sc1
    buffer_load_dwordx4 v[88:91], v252, s[20:23], s49 offen offset:16 sc1
Lps1:
    s_nop 7
    v_pk_add_f32 v[208:209], v[176:177], v[200:201]
    v_pk_add_f32 v[212:213], v[180:181], v[204:205] neg_lo:[0,1] neg_hi:[0,1]
    v_pk_add_f32 v[216:217], v[176:177], v[200:201] neg_lo:[0,1] neg_hi:[0,1]
    v_pk_add_f32 v[220:221], v[180:181], v[204:205]
    v_pk_add_f32 v[210:211], v[178:179], v[202:203]
    v_pk_add_f32 v[214:215], v[182:183], v[206:207] neg_lo:[0,1] neg_hi:[0,1]
    v_pk_add_f32 v[218:219], v[178:179], v[202:203] neg_lo:[0,1] neg_hi:[0,1]
    v_pk_add_f32 v[222:223], v[182:183], v[206:207]
    v_pk_add_f32 v[224:225], v[184:185], v[192:193]
    v_pk_add_f32 v[228:229], v[188:189], v[196:197] neg_lo:[0,1] neg_hi:[0,1]
    v_pk_add_f32 v[232:233], v[184:185], v[192:193] neg_lo:[0,1] neg_hi:[0,1]
    v_pk_add_f32 v[236:237], v[188:189], v[196:197]
    v_pk_add_f32 v[226:227], v[186:187], v[194:195]
    v_pk_add_f32 v[230:231], v[190:191], v[198:199] neg_lo:[0,1] neg_hi:[0,1]
    v_pk_add_f32 v[234:235], v[186:187], v[194:195] neg_lo:[0,1] neg_hi:[0,1]
    v_pk_add_f32 v[238:239], v[190:191], v[198:199]
    v_pk_add_f32 v[144:145], v[208:209], v[224:225]
    v_pk_add_f32 v[148:149], v[212:213], v[228:229]
    v_pk_add_f32 v[192:193], v[208:209], v[224:225] neg_lo:[0,1] neg_hi:[0,1]
    v_pk_add_f32 v[196:197], v[212:213], v[228:229] neg_lo:[0,1] neg_hi:[0,1]
    v_pk_add_f32 v[184:185], v[216:217], v[236:237] neg_lo:[0,1] neg_hi:[0,1]
    v_pk_add_f32 v[188:189], v[220:221], v[232:233]
    v_pk_add_f32 v[200:201], v[216:217], v[236:237]
    v_pk_add_f32 v[204:205], v[220:221], v[232:233] neg_lo:[0,1] neg_hi:[0,1]
    v_pk_add_f32 v[146:147], v[210:211], v[226:227]
    v_pk_add_f32 v[150:151], v[214:215], v[230:231]
    v_pk_add_f32 v[194:195], v[210:211], v[226:227] neg_lo:[0,1] neg_hi:[0,1]
    v_pk_add_f32 v[198:199], v[214:215], v[230:231] neg_lo:[0,1] neg_hi:[0,1]
    v_pk_add_f32 v[186:187], v[218:219], v[238:239] neg_lo:[0,1] neg_hi:[0,1]
    v_pk_add_f32 v[190:191], v[222:223], v[234:235]
    v_pk_add_f32 v[202:203], v[218:219], v[238:239]
    v_pk_add_f32 v[206:207], v[222:223], v[234:235] neg_lo:[0,1] neg_hi:[0,1]
    v_cvt_pk_bf16_f32 v208, v144, v145
    v_cvt_pk_bf16_f32 v209, v146, v147
    v_cvt_pk_bf16_f32 v210, v148, v149
    v_cvt_pk_bf16_f32 v211, v150, v151
    ds_write_b128 v14, v[208:211] offset:0
    v_pk_mul_f32 v[152:153], v[184:185], v[28:29]
    v_pk_mul_f32 v[156:157], v[184:185], v[32:33]
    v_pk_mul_f32 v[154:155], v[186:187], v[30:31]
    v_pk_mul_f32 v[158:159], v[186:187], v[34:35]
    v_pk_fma_f32 v[152:153], v[188:189], v[32:33], v[152:153] neg_lo:[1,0,0] neg_hi:[1,0,0]
    v_pk_fma_f32 v[156:157], v[188:189], v[28:29], v[156:157]
    v_pk_fma_f32 v[154:155], v[190:191], v[34:35], v[154:155] neg_lo:[1,0,0] neg_hi:[1,0,0]
    v_pk_fma_f32 v[158:159], v[190:191], v[30:31], v[158:159]
    v_cvt_pk_bf16_f32 v212, v152, v153
    v_cvt_pk_bf16_f32 v213, v154, v155
    v_cvt_pk_bf16_f32 v214, v156, v157
    v_cvt_pk_bf16_f32 v215, v158, v159
    ds_write_b128 v14, v[212:215] offset:1024
    v_pk_mul_f32 v[160:161], v[192:193], v[36:37]
    v_pk_mul_f32 v[164:165], v[192:193], v[40:41]
    v_pk_mul_f32 v[162:163], v[194:195], v[38:39]
    v_pk_mul_f32 v[166:167], v[194:195], v[42:43]
    v_pk_fma_f32 v[160:161], v[196:197], v[40:41], v[160:161] neg_lo:[1,0,0] neg_hi:[1,0,0]
    v_pk_fma_f32 v[164:165], v[196:197], v[36:37], v[164:165]
    v_pk_fma_f32 v[162:163], v[198:199], v[42:43], v[162:163] neg_lo:[1,0,0] neg_hi:[1,0,0]
    v_pk_fma_f32 v[166:167], v[198:199], v[38:39], v[166:167]
    v_cvt_pk_bf16_f32 v216, v160, v161
    v_cvt_pk_bf16_f32 v217, v162, v163
    v_cvt_pk_bf16_f32 v218, v164, v165
    v_cvt_pk_bf16_f32 v219, v166, v167
    ds_write_b128 v14, v[216:219] offset:2048
    v_pk_mul_f32 v[168:169], v[200:201], v[44:45]
    v_pk_mul_f32 v[172:173], v[200:201], v[48:49]
    v_pk_mul_f32 v[170:171], v[202:203], v[46:47]
    v_pk_mul_f32 v[174:175], v[202:203], v[50:51]
    v_pk_fma_f32 v[168:169], v[204:205], v[48:49], v[168:169] neg_lo:[1,0,0] neg_hi:[1,0,0]
    v_pk_fma_f32 v[172:173], v[204:205], v[44:45], v[172:173]
    v_pk_fma_f32 v[170:171], v[206:207], v[50:51], v[170:171] neg_lo:[1,0,0] neg_hi:[1,0,0]
    v_pk_fma_f32 v[174:175], v[206:207], v[46:47], v[174:175]
    v_cvt_pk_bf16_f32 v220, v168, v169
    v_cvt_pk_bf16_f32 v221, v170, v171
    v_cvt_pk_bf16_f32 v222, v172, v173
    v_cvt_pk_bf16_f32 v223, v174, v175
    ds_write_b128 v14, v[220:223] offset:3072
    s_waitcnt lgkmcnt(0)
    s_branch Lp3_z
Lp3_nf3:
    s_cmp_lt_u32 s28, 3
    s_cbranch_scc1 Lps2
    s_cmp_lg_u32 s40, 0
    s_cbranch_scc1 Lps2
    s_mov_b32 s3, 0
Lpr2:
    s_waitcnt vmcnt(0)
    v_cmp_eq_u64 vcc, s[98:99], v[254:255]
    s_add_u32 s3, s3, 1
    s_nop 0
    s_andn2_b64 s[38:39], s[38:39], vcc
    s_cbranch_scc0 Lpo2
    s_mov_b64 exec, s[38:39]
    v_mov_b32 v254, 0
    v_mov_b32 v255, 0
    buffer_atomic_add_x2 v[254:255], v253, s[52:55], s43 offen sc0 sc1
    s_mov_b64 exec, -1
    s_branch Lps2
Lpo2:
    s_mov_b32 s40, 1
    buffer_load_dwordx4 v[76:79], v252, s[20:23], s50 offen offset:0 sc1
    buffer_load_dwordx4 v[84:87], v252, s[20:23], s49 offen offset:0 sc1
    buffer_load_dwordx4 v[80:83], v252, s[20:23], s50 offen offset:16 sc1
    buffer_load_dwordx4 v[88:91], v252, s[20:23], s49 offen offset:16 sc1
Lps2:
Lp3_z:
    s_barrier
    s_cmp_lt_u32 s28, 3
    s_cbranch_scc1 Lk1_end
    s_mov_b32 s36, 0xbfb8aa3b
    s_mov_b32 s37, 0x49200000
    v_add_u32 v4, 49152, v3
    ds_read_b128 v[144:147], v4 offset:0
    ds_read_b128 v[148:151], v4 offset:1024
    ds_read_b128 v[152:155], v4 offset:2048
    ds_read_b128 v[156:159], v4 offset:3072
    ds_read_b128 v[160:163], v4 offset:4096
    ds_read_b128 v[164:167], v4 offset:5120
    ds_read_b128 v[168:171], v4 offset:6144
    ds_read_b128 v[172:175], v4 offset:7168
    ds_read_b128 v[176:179], v4 offset:8192
    ds_read_b128 v[180:183], v4 offset:9216
    ds_read_b128 v[184:187], v4 offset:10240
    ds_read_b128 v[188:191], v4 offset:11264
    ds_read_b128 v[192:195], v4 offset:12288
    ds_read_b128 v[196:199], v4 offset:13312
    ds_read_b128 v[200:203], v4 offset:14336
    ds_read_b128 v[204:207], v4 offset:15360
    ds_read_b128 v[208:211], v4 offset:16384
    ds_read_b128 v[212:215], v4 offset:17408
    ds_read_b128 v[216:219], v4 offset:18432
    ds_read_b128 v[220:223], v4 offset:19456
    ds_read_b128 v[224:227], v4 offset:20480
    ds_read_b128 v[228:231], v4 offset:21504
    ds_read_b128 v[232:235], v4 offset:22528
    ds_read_b128 v[236:239], v4 offset:23552
    s_waitcnt lgkmcnt(15)
    v_mfma_f32_16x16x32_bf16 v[124:127], v[144:147], v[52:55], 0
    v_mfma_f32_16x16x32_bf16 v[128:131], v[148:151], v[52:55], 0
    v_mfma_f32_16x16x32_bf16 v[132:135], v[152:155], v[52:55], 0
    v_mfma_f32_16x16x32_bf16 v[136:139], v[156:159], v[52:55], 0
    s_waitcnt lgkmcnt(15)
    v_mfma_f32_16x16x32_bf16 v[124:127], v[160:163], v[56:59], v[124:127]
    v_mfma_f32_16x16x32_bf16 v[128:131], v[164:167], v[56:59], v[128:131]
    v_mfma_f32_16x16x32_bf16 v[132:135], v[168:171], v[56:59], v[132:135]
    v_mfma_f32_16x16x32_bf16 v[136:139], v[172:175], v[56:59], v[136:139]
    s_waitcnt lgkmcnt(12)
    v_mfma_f32_16x16x32_bf16 v[124:127], v[176:179], v[60:63], v[124:127]
    v_mfma_f32_16x16x32_bf16 v[128:131], v[180:183], v[60:63], v[128:131]
    v_mfma_f32_16x16x32_bf16 v[132:135], v[184:187], v[60:63], v[132:135]
    v_mfma_f32_16x16x32_bf16 v[136:139], v[188:191], v[60:63], v[136:139]
    s_waitcnt lgkmcnt(8)
    v_mfma_f32_16x16x32_bf16 v[124:127], v[192:195], v[64:67], v[124:127]
    v_mfma_f32_16x16x32_bf16 v[128:131], v[196:199], v[64:67], v[128:131]
    v_mfma_f32_16x16x32_bf16 v[132:135], v[200:203], v[64:67], v[132:135]
    v_mfma_f32_16x16x32_bf16 v[136:139], v[204:207], v[64:67], v[136:139]
    s_waitcnt lgkmcnt(4)
    v_mfma_f32_16x16x32_bf16 v[124:127], v[208:211], v[68:71], v[124:127]
    v_mfma_f32_16x16x32_bf16 v[128:131], v[212:215], v[68:71], v[128:131]
    v_mfma_f32_16x16x32_bf16 v[132:135], v[216:219], v[68:71], v[132:135]
    v_mfma_f32_16x16x32_bf16 v[136:139], v[220:223], v[68:71], v[136:139]
    s_waitcnt lgkmcnt(0)
    v_mfma_f32_16x16x32_bf16 v[124:127], v[224:227], v[72:75], v[124:127]
    v_mfma_f32_16x16x32_bf16 v[128:131], v[228:231], v[72:75], v[128:131]
    v_mfma_f32_16x16x32_bf16 v[132:135], v[232:235], v[72:75], v[132:135]
    v_mfma_f32_16x16x32_bf16 v[136:139], v[236:239], v[72:75], v[136:139]
    s_cmp_lt_u32 s28, 3
    s_cbranch_scc1 Lps3
    s_cmp_lg_u32 s40, 0
    s_cbranch_scc1 Lps3
    s_mov_b32 s3, 0
Lpr3:
    s_waitcnt vmcnt(0)
    v_cmp_eq_u64 vcc, s[98:99], v[254:255]
    s_add_u32 s3, s3, 1
    s_nop 0
    s_andn2_b64 s[38:39], s[38:39], vcc
    s_cbranch_scc0 Lpo3
    s_mov_b64 exec, s[38:39]
    v_mov_b32 v254, 0
    v_mov_b32 v255, 0
    buffer_atomic_add_x2 v[254:255], v253, s[52:55], s43 offen sc0 sc1
    s_mov_b64 exec, -1
    s_cmp_lt_u32 s3, 131072
    s_cbranch_scc1 Lpr3
Lpo3:
    s_mov_b32 s40, 1
    buffer_load_dwordx4 v[76:79], v252, s[20:23], s50 offen offset:0 sc1
    buffer_load_dwordx4 v[84:87], v252, s[20:23], s49 offen offset:0 sc1
    buffer_load_dwordx4 v[80:83], v252, s[20:23], s50 offen offset:16 sc1
    buffer_load_dwordx4 v[88:91], v252, s[20:23], s49 offen offset:16 sc1
Lps3:
    v_lshlrev_b32 v108, 16, v240
    v_and_b32 v109, 0xffff0000, v240
    v_lshlrev_b32 v110, 16, v241
    v_and_b32 v111, 0xffff0000, v241
    v_lshlrev_b32 v112, 16, v242
    v_and_b32 v113, 0xffff0000, v242
    v_lshlrev_b32 v114, 16, v243
    v_and_b32 v115, 0xffff0000, v243
    v_lshlrev_b32 v116, 16, v244
    v_and_b32 v117, 0xffff0000, v244
    v_lshlrev_b32 v118, 16, v245
    v_and_b32 v119, 0xffff0000, v245
    v_lshlrev_b32 v120, 16, v246
    v_and_b32 v121, 0xffff0000, v246
    v_lshlrev_b32 v122, 16, v247
    v_and_b32 v123, 0xffff0000, v247
    s_waitcnt vmcnt(2)
    v_lshlrev_b32 v92, 16, v76
    v_and_b32 v93, 0xffff0000, v76
    v_lshlrev_b32 v16, 16, v84
    v_and_b32 v17, 0xffff0000, v84
    v_lshlrev_b32 v94, 16, v77
    v_and_b32 v95, 0xffff0000, v77
    v_lshlrev_b32 v18, 16, v85
    v_and_b32 v19, 0xffff0000, v85
    v_lshlrev_b32 v96, 16, v78
    v_and_b32 v97, 0xffff0000, v78
    v_lshlrev_b32 v20, 16, v86
    v_and_b32 v21, 0xffff0000, v86
    v_lshlrev_b32 v98, 16, v79
    v_and_b32 v99, 0xffff0000, v79
    v_lshlrev_b32 v22, 16, v87
    v_and_b32 v23, 0xffff0000, v87
    v_pk_add_f32 v[92:93], v[92:93], v[16:17]
    v_pk_add_f32 v[94:95], v[94:95], v[18:19]
    v_pk_add_f32 v[96:97], v[96:97], v[20:21]
    v_pk_add_f32 v[98:99], v[98:99], v[22:23]
    v_pk_mul_f32 v[16:17], v[92:93], s[36:37] op_sel_hi:[1,0]
    v_pk_mul_f32 v[18:19], v[94:95], s[36:37] op_sel_hi:[1,0]
    v_pk_mul_f32 v[20:21], v[96:97], s[36:37] op_sel_hi:[1,0]
    v_pk_mul_f32 v[22:23], v[98:99], s[36:37] op_sel_hi:[1,0]
    v_exp_f32 v16, v16
    v_exp_f32 v17, v17
    v_exp_f32 v18, v18
    v_exp_f32 v19, v19
    v_exp_f32 v20, v20
    v_exp_f32 v21, v21
    v_exp_f32 v22, v22
    v_exp_f32 v23, v23
    v_pk_fma_f32 v[16:17], v[16:17], s[36:37], s[36:37] op_sel:[0,1,1] op_sel_hi:[1,1,1]
    v_pk_fma_f32 v[18:19], v[18:19], s[36:37], s[36:37] op_sel:[0,1,1] op_sel_hi:[1,1,1]
    v_pk_fma_f32 v[20:21], v[20:21], s[36:37], s[36:37] op_sel:[0,1,1] op_sel_hi:[1,1,1]
    v_pk_fma_f32 v[22:23], v[22:23], s[36:37], s[36:37] op_sel:[0,1,1] op_sel_hi:[1,1,1]
    v_rcp_f32 v16, v16
    v_rcp_f32 v17, v17
    v_rcp_f32 v18, v18
    v_rcp_f32 v19, v19
    v_rcp_f32 v20, v20
    v_rcp_f32 v21, v21
    v_rcp_f32 v22, v22
    v_rcp_f32 v23, v23
    v_pk_mul_f32 v[92:93], v[92:93], v[16:17]
    v_pk_mul_f32 v[94:95], v[94:95], v[18:19]
    v_pk_mul_f32 v[96:97], v[96:97], v[20:21]
    v_pk_mul_f32 v[98:99], v[98:99], v[22:23]
    s_waitcnt vmcnt(0)
    v_lshlrev_b32 v100, 16, v80
    v_and_b32 v101, 0xffff0000, v80
    v_lshlrev_b32 v16, 16, v88
    v_and_b32 v17, 0xffff0000, v88
    v_lshlrev_b32 v102, 16, v81
    v_and_b32 v103, 0xffff0000, v81
    v_lshlrev_b32 v18, 16, v89
    v_and_b32 v19, 0xffff0000, v89
    v_lshlrev_b32 v104, 16, v82
    v_and_b32 v105, 0xffff0000, v82
    v_lshlrev_b32 v20, 16, v90
    v_and_b32 v21, 0xffff0000, v90
    v_lshlrev_b32 v106, 16, v83
    v_and_b32 v107, 0xffff0000, v83
    v_lshlrev_b32 v22, 16, v91
    v_and_b32 v23, 0xffff0000, v91
    v_pk_add_f32 v[100:101], v[100:101], v[16:17]
    v_pk_add_f32 v[102:103], v[102:103], v[18:19]
    v_pk_add_f32 v[104:105], v[104:105], v[20:21]
    v_pk_add_f32 v[106:107], v[106:107], v[22:23]
    v_pk_mul_f32 v[16:17], v[100:101], s[36:37] op_sel_hi:[1,0]
    v_pk_mul_f32 v[18:19], v[102:103], s[36:37] op_sel_hi:[1,0]
    v_pk_mul_f32 v[20:21], v[104:105], s[36:37] op_sel_hi:[1,0]
    v_pk_mul_f32 v[22:23], v[106:107], s[36:37] op_sel_hi:[1,0]
    v_exp_f32 v16, v16
    v_exp_f32 v17, v17
    v_exp_f32 v18, v18
    v_exp_f32 v19, v19
    v_exp_f32 v20, v20
    v_exp_f32 v21, v21
    v_exp_f32 v22, v22
    v_exp_f32 v23, v23
    v_pk_fma_f32 v[16:17], v[16:17], s[36:37], s[36:37] op_sel:[0,1,1] op_sel_hi:[1,1,1]
    v_pk_fma_f32 v[18:19], v[18:19], s[36:37], s[36:37] op_sel:[0,1,1] op_sel_hi:[1,1,1]
    v_pk_fma_f32 v[20:21], v[20:21], s[36:37], s[36:37] op_sel:[0,1,1] op_sel_hi:[1,1,1]
    v_pk_fma_f32 v[22:23], v[22:23], s[36:37], s[36:37] op_sel:[0,1,1] op_sel_hi:[1,1,1]
    v_rcp_f32 v16, v16
    v_rcp_f32 v17, v17
    v_rcp_f32 v18, v18
    v_rcp_f32 v19, v19
    v_rcp_f32 v20, v20
    v_rcp_f32 v21, v21
    v_rcp_f32 v22, v22
    v_rcp_f32 v23, v23
    v_pk_mul_f32 v[100:101], v[100:101], v[16:17]
    v_pk_mul_f32 v[102:103], v[102:103], v[18:19]
    v_pk_mul_f32 v[104:105], v[104:105], v[20:21]
    v_pk_mul_f32 v[106:107], v[106:107], v[22:23]
    v_fmac_f32 v108, v124, v92
    v_fmac_f32 v109, v128, v96
    v_fmac_f32 v110, v132, v100
    v_fmac_f32 v111, v136, v104
    v_cvt_pk_bf16_f32 v240, v108, v109
    v_cvt_pk_bf16_f32 v241, v110, v111
    buffer_store_dwordx2 v[240:241], v6, s[24:27], s44 offen
    v_fmac_f32 v112, v125, v93
    v_fmac_f32 v113, v129, v97
    v_fmac_f32 v114, v133, v101
    v_fmac_f32 v115, v137, v105
    v_cvt_pk_bf16_f32 v242, v112, v113
    v_cvt_pk_bf16_f32 v243, v114, v115
    buffer_store_dwordx2 v[242:243], v6, s[24:27], s45 offen
    v_fmac_f32 v116, v126, v94
    v_fmac_f32 v117, v130, v98
    v_fmac_f32 v118, v134, v102
    v_fmac_f32 v119, v138, v106
    v_cvt_pk_bf16_f32 v244, v116, v117
    v_cvt_pk_bf16_f32 v245, v118, v119
    buffer_store_dwordx2 v[244:245], v6, s[24:27], s46 offen
    v_fmac_f32 v120, v127, v95
    v_fmac_f32 v121, v131, v99
    v_fmac_f32 v122, v135, v103
    v_fmac_f32 v123, v139, v107
    v_cvt_pk_bf16_f32 v246, v120, v121
    v_cvt_pk_bf16_f32 v247, v122, v123
    buffer_store_dwordx2 v[246:247], v6, s[24:27], s47 offen
Lk1_end:
    s_endpgm
Lk1_end_x:
    s_endpgm
.section .rodata,"a"
.p2align 6
.amdhsa_kernel recurrent_scan__spectral_gfnet__dense_activation_gelu__prompt_kernel
  .amdhsa_next_free_vgpr 256
  .amdhsa_next_free_sgpr 100
  .amdhsa_accum_offset 256
  .amdhsa_group_segment_fixed_size 0
  .amdhsa_kernarg_size 88
  .amdhsa_user_sgpr_count 2
  .amdhsa_user_sgpr_kernarg_segment_ptr 1
  .amdhsa_system_sgpr_workgroup_id_x 1
.end_amdhsa_kernel
```
